```python
import torch

def _softmax(x, axis=-1):
    return torch.softmax(x, dim=axis)
def _gelu(x):
    return torch.nn.functional.gelu(x, approximate="tanh")
def _silu(x):
    return torch.nn.functional.silu(x)
def _sigmoid(x):
    return torch.sigmoid(x)
def _layernorm(x, axis=-1, eps=1e-5):
    m = x.mean(dim=axis, keepdim=True)
    v = x.var(dim=axis, keepdim=True, unbiased=False)
    return (x - m) / torch.sqrt(v + eps)
def _scatter_add(tgt, idx, src, axis=0):
    return tgt.clone().index_add_(axis, idx, src)
def _segment_sum(src, seg, n):
    out = torch.zeros((n,) + src.shape[1:], dtype=src.dtype)
    return out.index_add_(0, seg, src)
def _pad(x, pw):
    flat = tuple(v for pair in reversed(pw) for v in pair)
    return torch.nn.functional.pad(x, flat)

kernel_name = 'standalone__dense_activation_relu__prompt'

def setup_inputs():

    _w = (lambda a: (lambda t: t.to(torch.bfloat16) if t.is_floating_point() else t)(torch.as_tensor(a)))
    B, S, D, Dff = 1, 2048, 512, 1792
    return {
        "x": _w((lambda *s: torch.randn(*s, dtype=torch.bfloat16) * 0.05)(B, S, D)),
        "w1": _w((lambda *s: torch.randn(*s, dtype=torch.bfloat16) * 0.05)(D, Dff)),
        "w2": _w((lambda *s: torch.randn(*s, dtype=torch.bfloat16) * 0.05)(Dff, D)),
    }

def reference(x, w1, w2):
    h = torch.einsum("bsd,df->bsf", x, w1)
    zero = torch.zeros_like(h)
    h = torch.maximum(h, zero)
    return torch.einsum("bsf,fd->bsd", h, w2)
```

```asm
; @launch grid=(256,1,1) block=(256,1,1) lds=163840
.amdgcn_target "amdgcn-amd-amdhsa--gfx950"
.text
.globl standalone__dense_activation_relu__prompt_kernel
.p2align 8
.type standalone__dense_activation_relu__prompt_kernel,@function
standalone__dense_activation_relu__prompt_kernel:
    s_load_dwordx8 s[4:11], s[0:1], 0
    s_load_dwordx4 s[12:15], s[0:1], 32
    s_memrealtime s[82:83]
    s_cmp_ge_u32 s2, 256
    s_cbranch_scc1 L_end
    v_lshrrev_b32 v232, 6, v0
    v_and_b32 v1, 63, v0
    s_and_b32 s41, s2, 7
    v_readfirstlane_b32 s40, v232
    s_lshr_b32 s42, s2, 3
    s_cmp_lt_u32 s42, 31
    s_cbranch_scc1 L_nocpf
    s_getpc_b64 s[20:21]
L_pc:
    v_lshlrev_b32 v32, 7, v0
    v_mov_b32 v35, s21
    v_add_co_u32 v34, vcc, s20, v32
    s_nop 1
    v_addc_co_u32 v35, vcc, 0, v35, vcc
    v_cmp_gt_u32 vcc, L_code_end-L_pc, v32
    s_and_saveexec_b64 s[22:23], vcc
    s_cbranch_execz L_cpf_done
    global_load_dword v33, v[34:35], off
L_cpf_done:
    s_mov_b64 exec, s[22:23]
L_nocpf:
    s_and_b32 s3, s42, 3
    s_lshr_b32 s44, s42, 2
    s_add_u32 s45, s3, s44
    s_lshl_b32 s45, s45, 2
    s_and_b32 s46, s41, 6
    s_lshl_b32 s46, s46, 1
    s_add_u32 s48, s3, s46
    s_and_b32 s46, s41, 1
    s_mul_i32 s46, s46, 7
    s_add_u32 s63, s44, s46
    s_lshl_b32 s43, s48, 17
    s_lshl_b32 s44, s63, 8
    s_add_u32 s46, s45, 0
    s_and_b32 s46, s46, 7
    s_mul_i32 s72, s46, 229376
    s_lshl_b32 s46, s46, 7
    s_add_u32 s64, s46, s43
    s_add_u32 s72, s72, s44
    s_add_u32 s46, s45, 1
    s_and_b32 s46, s46, 7
    s_mul_i32 s73, s46, 229376
    s_lshl_b32 s46, s46, 7
    s_add_u32 s65, s46, s43
    s_add_u32 s73, s73, s44
    s_lshl_b32 s47, s40, 12
    s_lshl_b32 s55, s40, 13
    v_lshrrev_b32 v232, 4, v1
    v_and_b32 v233, 15, v1
    v_lshlrev_b32 v234, 1, v232
    v_xor_b32 v233, v233, v234
    v_lshlrev_b32 v233, 4, v233
    s_lshl_b32 s46, s40, 4
    v_add_u32 v234, s46, v232
    v_mul_u32_u24 v234, 3584, v234
    v_add_u32 v6, v233, v234
    v_xor_b32 v233, 128, v233
    v_add_u32 v233, v233, v234
    v_add_u32 v7, 13312, v6
    v_add_u32 v8, 26624, v233
    v_add_u32 v9, 39936, v233
    v_and_b32 v233, 7, v1
    v_xor_b32 v234, v233, v232
    v_lshlrev_b32 v234, 4, v234
    v_lshrrev_b32 v235, 3, v1
    s_lshl_b32 s46, s40, 15
    v_lshl_add_u32 v236, v235, 10, s46
    v_add_u32 v2, v236, v234
    v_xor_b32 v234, 64, v234
    v_add_u32 v234, v236, v234
    v_add_u32 v3, 7168, v234
    v_add_u32 v4, 14336, v2
    v_add_u32 v5, 21504, v234
    s_waitcnt lgkmcnt(0)
    s_mov_b32 s20, s6
    s_mov_b32 s21, s7
    s_mov_b32 s22, 0x1c0000
    s_mov_b32 s23, 0x20000
    s_mov_b32 s16, s4
    s_mov_b32 s17, s5
    s_mov_b32 s18, 0x200000
    s_mov_b32 s19, 0x20000
    s_cmp_ge_u32 s42, 28
    s_cbranch_scc1 L_early_idle
    s_add_u32 m0, s47, 0
    s_nop 0
    buffer_load_dwordx4 v6, s[20:23], s72 offen offset:0 lds
    buffer_load_dwordx4 v7, s[20:23], s72 offen offset:1024 lds
    buffer_load_dwordx4 v8, s[20:23], s72 offen offset:2048 lds
    buffer_load_dwordx4 v9, s[20:23], s72 offen offset:3072 lds
    s_add_u32 m0, s47, 16384
    s_nop 0
    buffer_load_dwordx4 v2, s[16:19], s64 offen offset:0 lds
    buffer_load_dwordx4 v3, s[16:19], s64 offen offset:1024 lds
    buffer_load_dwordx4 v4, s[16:19], s64 offen offset:2048 lds
    buffer_load_dwordx4 v5, s[16:19], s64 offen offset:3072 lds
    s_add_u32 m0, s47, 32768
    s_nop 0
    buffer_load_dwordx4 v6, s[20:23], s73 offen offset:0 lds
    buffer_load_dwordx4 v7, s[20:23], s73 offen offset:1024 lds
    buffer_load_dwordx4 v8, s[20:23], s73 offen offset:2048 lds
L_setup2:
    s_mov_b32 s32, s12
    s_mov_b32 s33, s13
    s_mov_b32 s34, 0x100
    s_mov_b32 s35, 0x20000
    v_mov_b32 v18, 0
    s_or_b32 s46, s2, s40
    s_cmp_lg_u32 s46, 0
    s_cbranch_scc1 L_nonce_done
    s_or_b32 s83, s83, 0x80000000
    s_atomic_swap_x2 s[82:83], s[12:13], 0
    s_waitcnt lgkmcnt(0)
L_nonce_done:
    s_add_u32 s46, s45, 2
    s_and_b32 s46, s46, 7
    s_mul_i32 s74, s46, 229376
    s_lshl_b32 s46, s46, 7
    s_add_u32 s66, s46, s43
    s_add_u32 s74, s74, s44
    s_add_u32 s46, s45, 3
    s_and_b32 s46, s46, 7
    s_mul_i32 s75, s46, 229376
    s_lshl_b32 s46, s46, 7
    s_add_u32 s67, s46, s43
    s_add_u32 s75, s75, s44
    s_add_u32 s46, s45, 4
    s_and_b32 s46, s46, 7
    s_mul_i32 s76, s46, 229376
    s_lshl_b32 s46, s46, 7
    s_add_u32 s68, s46, s43
    s_add_u32 s76, s76, s44
    s_add_u32 s46, s45, 5
    s_and_b32 s46, s46, 7
    s_mul_i32 s77, s46, 229376
    s_lshl_b32 s46, s46, 7
    s_add_u32 s69, s46, s43
    s_add_u32 s77, s77, s44
    s_add_u32 s46, s45, 6
    s_and_b32 s46, s46, 7
    s_mul_i32 s78, s46, 229376
    s_lshl_b32 s46, s46, 7
    s_add_u32 s70, s46, s43
    s_add_u32 s78, s78, s44
    s_add_u32 s46, s45, 7
    s_and_b32 s46, s46, 7
    s_mul_i32 s79, s46, 229376
    s_lshl_b32 s46, s46, 7
    s_add_u32 s71, s46, s43
    s_add_u32 s79, s79, s44
    s_mov_b32 s24, s8
    s_mov_b32 s25, s9
    s_mov_b32 s26, 0x1c0000
    s_mov_b32 s27, 0x20000
    s_mov_b32 s28, s10
    s_mov_b32 s29, s11
    s_mov_b32 s30, 0x200000
    s_mov_b32 s31, 0x20000
    s_mov_b32 s36, s14
    s_mov_b32 s37, s15
    s_mov_b32 s38, 0x10000000
    s_mov_b32 s39, 0x20000
    s_lshr_b32 s43, s40, 1
    s_and_b32 s44, s40, 1
    s_lshl_b32 s45, s48, 1
    s_add_u32 s45, s45, s43
    s_lshl_b32 s46, s63, 1
    s_add_u32 s46, s46, s44
    s_mul_i32 s4, s46, 37
    s_lshr_b32 s4, s4, 8
    s_mul_i32 s5, s4, 7
    s_sub_u32 s5, s46, s5
    s_lshl_b32 s6, s45, 2
    s_add_u32 s4, s4, s6
    s_lshl_b32 s4, s4, 7
    s_lshl_b32 s5, s5, 3
    s_add_u32 s4, s4, s5
    s_add_u32 s4, s4, 0x800000
    s_add_u32 s8, s14, s4
    s_addc_u32 s9, s15, 0
    s_mul_i32 s45, s45, 229376
    s_lshl_b32 s46, s46, 11
    s_add_u32 s45, s45, s46
    v_lshl_add_u32 v22, v1, 4, s45
    v_and_b32 v234, 15, v1
    v_lshrrev_b32 v237, 1, v234
    v_xor_b32 v237, v237, v232
    v_lshlrev_b32 v237, 4, v237
    v_lshl_add_u32 v237, v234, 7, v237
    s_lshl_b32 s45, s43, 13
    v_add_u32 v192, s45, v237
    v_xor_b32 v193, 64, v192
    v_add_u32 v194, 65536, v192
    v_add_u32 v195, 65536, v193
    v_add_u32 v196, 131072, v192
    v_add_u32 v197, 131072, v193
    v_xor_b32 v237, v233, v232
    v_lshlrev_b32 v237, 4, v237
    v_lshl_add_u32 v237, v234, 8, v237
    v_add_u32 v24, s55, v237
    v_xor_b32 v25, 64, v24
    s_lshl_b32 s45, s40, 2
    v_add_u32 v237, s45, v232
    v_and_b32 v238, 7, v237
    v_xor_b32 v238, v238, v234
    v_lshlrev_b32 v238, 4, v238
    v_lshl_add_u32 v26, v237, 8, v238
    v_lshlrev_b32 v238, 3, v234
    v_lshl_add_u32 v23, v237, 10, v238
    v_bfe_u32 v234, v1, 2, 2
    v_and_b32 v236, 3, v1
    v_lshlrev_b32 v236, 3, v236
    v_and_b32 v237, 1, v232
    v_lshl_add_u32 v237, v237, 2, v234
    s_lshl_b32 s45, s44, 2
    v_xor_b32 v237, s45, v237
    v_lshl_add_u32 v237, v237, 5, v236
    v_lshl_add_u32 v238, v232, 3, v234
    v_lshl_add_u32 v198, v238, 8, v237
    v_xor_b32 v199, 32, v198
    v_xor_b32 v200, 64, v198
    v_xor_b32 v201, 96, v198
    v_add_u32 v202, 65536, v198
    v_add_u32 v203, 65536, v199
    v_add_u32 v204, 65536, v200
    v_add_u32 v205, 65536, v201
    v_add_u32 v206, 131072, v198
    v_add_u32 v207, 131072, v199
    v_add_u32 v208, 131072, v200
    v_add_u32 v209, 131072, v201
    v_lshl_add_u32 v238, v232, 2, v234
    v_bfe_u32 v237, v238, 1, 2
    v_lshl_add_u32 v237, v237, 5, v236
    v_lshl_add_u32 v237, v238, 7, v237
    v_add_u32 v210, s55, v237
    v_xor_b32 v211, 32, v210
    v_xor_b32 v212, 64, v210
    v_xor_b32 v213, 96, v210
    v_add_u32 v214, 65536, v210
    v_add_u32 v215, 65536, v211
    v_add_u32 v216, 65536, v212
    v_add_u32 v217, 65536, v213
    v_add_u32 v218, 131072, v210
    v_add_u32 v219, 131072, v211
    v_add_u32 v220, 131072, v212
    v_add_u32 v221, 131072, v213
    s_lshl_b32 s5, s41, 2
    s_add_u32 s43, s3, s5
    s_lshr_b32 s4, s42, 2
    s_cmp_ge_u32 s4, 3
    s_addc_u32 s44, s4, 0
    s_cmp_eq_u32 s4, 7
    s_cselect_b32 s44, 3, s44
    s_lshr_b32 s4, s44, 1
    s_add_u32 s4, s4, s3
    s_and_b32 s45, s4, 3
    s_and_b32 s11, s44, 1
    s_mul_i32 s46, s40, 7
    s_add_u32 s5, s45, 0
    s_and_b32 s5, s5, 3
    s_add_u32 s5, s5, s46
    s_add_u32 s5, s5, 2
    s_lshl_b32 s56, s5, 16
    s_lshl_b32 s48, s5, 11
    s_add_u32 s5, s45, 1
    s_and_b32 s5, s5, 3
    s_add_u32 s5, s5, s46
    s_add_u32 s5, s5, 2
    s_lshl_b32 s57, s5, 16
    s_lshl_b32 s49, s5, 11
    s_add_u32 s5, s45, 2
    s_and_b32 s5, s5, 3
    s_add_u32 s5, s5, s46
    s_add_u32 s5, s5, 2
    s_lshl_b32 s58, s5, 16
    s_lshl_b32 s50, s5, 11
    s_add_u32 s5, s45, 3
    s_and_b32 s5, s5, 3
    s_add_u32 s5, s5, s46
    s_add_u32 s5, s5, 2
    s_lshl_b32 s59, s5, 16
    s_lshl_b32 s51, s5, 11
    s_add_u32 s5, s46, 6
    s_lshl_b32 s60, s5, 16
    s_lshl_b32 s52, s5, 11
    s_add_u32 s5, s46, 0
    s_lshl_b32 s61, s5, 16
    s_lshl_b32 s53, s5, 11
    s_add_u32 s5, s46, 1
    s_lshl_b32 s62, s5, 16
    s_lshl_b32 s54, s5, 11
    v_lshlrev_b32 v234, 1, v232
    v_xor_b32 v234, v233, v234
    v_lshlrev_b32 v234, 4, v234
    v_lshl_add_u32 v234, v235, 10, v234
    s_lshl_b32 s45, s44, 7
    v_add_u32 v10, s45, v234
    v_add_u32 v11, 7168, v10
    v_add_u32 v12, 14336, v10
    v_add_u32 v13, 21504, v10
    s_lshl_b32 s46, s43, 16
    s_add_u32 s45, s45, s46
    v_add_u32 v23, s45, v23
    s_lshl_b32 s45, s43, 2
    s_add_u32 s4, s11, 0
    s_and_b32 s4, s4, 3
    s_add_u32 s4, s4, s45
    s_mul_i32 s4, s4, 57344
    v_lshl_add_u32 v14, v1, 4, s4
    s_add_u32 s4, s11, 1
    s_and_b32 s4, s4, 3
    s_add_u32 s4, s4, s45
    s_mul_i32 s4, s4, 57344
    v_lshl_add_u32 v15, v1, 4, s4
    s_add_u32 s4, s11, 2
    s_and_b32 s4, s4, 3
    s_add_u32 s4, s4, s45
    s_mul_i32 s4, s4, 57344
    v_lshl_add_u32 v16, v1, 4, s4
    s_add_u32 s4, s11, 3
    s_and_b32 s4, s4, 3
    s_add_u32 s4, s4, s45
    s_mul_i32 s4, s4, 57344
    v_lshl_add_u32 v17, v1, 4, s4
    s_add_u32 s45, s45, s40
    s_lshl_b32 s45, s45, 7
    s_add_u32 s45, s45, 0x800000
    s_add_u32 s82, s14, s45
    s_addc_u32 s83, s15, 0
    s_load_dword s10, s[82:83], 0 glc
    s_cmp_ge_u32 s42, 28
    s_cbranch_scc1 L_idle
    s_add_u32 m0, s47, 32768
    s_nop 0
    buffer_load_dwordx4 v9, s[20:23], s73 offen offset:3072 lds
    s_add_u32 m0, s47, 49152
    s_nop 0
    buffer_load_dwordx4 v2, s[16:19], s65 offen offset:0 lds
    buffer_load_dwordx4 v3, s[16:19], s65 offen offset:1024 lds
    buffer_load_dwordx4 v4, s[16:19], s65 offen offset:2048 lds
    buffer_load_dwordx4 v5, s[16:19], s65 offen offset:3072 lds
    s_bitcmp1_b32 s42, 0
    s_cbranch_scc1 L_path2
    s_waitcnt vmcnt(8) lgkmcnt(0)
    s_barrier
    ds_read_b64_tr_b16 v[96:97], v198 offset:0
    ds_read_b64_tr_b16 v[98:99], v198 offset:1024
    ds_read_b128 v[112:115], v192 offset:16384
    ds_read_b128 v[116:119], v192 offset:18432
    ds_read_b128 v[120:123], v192 offset:20480
    ds_read_b128 v[124:127], v192 offset:22528
    ds_read_b64_tr_b16 v[100:101], v199 offset:0
    ds_read_b64_tr_b16 v[102:103], v199 offset:1024
    ds_read_b64_tr_b16 v[104:105], v200 offset:0
    ds_read_b64_tr_b16 v[106:107], v200 offset:1024
    s_add_u32 m0, s47, 65536
    s_nop 0
    buffer_load_dwordx4 v6, s[20:23], s74 offen offset:0 lds
    s_waitcnt lgkmcnt(4)
    v_mfma_f32_16x16x32_bf16 v[32:35], v[96:99], v[112:115], 0
    ds_read_b64_tr_b16 v[108:109], v201 offset:0
    v_mfma_f32_16x16x32_bf16 v[36:39], v[96:99], v[116:119], 0
    ds_read_b64_tr_b16 v[110:111], v201 offset:1024
    v_mfma_f32_16x16x32_bf16 v[40:43], v[96:99], v[120:123], 0
    ds_read_b64_tr_b16 v[128:129], v198 offset:8192
    buffer_load_dwordx4 v7, s[20:23], s74 offen offset:1024 lds
    v_mfma_f32_16x16x32_bf16 v[44:47], v[96:99], v[124:127], 0
    ds_read_b64_tr_b16 v[130:131], v198 offset:9216
    s_waitcnt lgkmcnt(6)
    v_mfma_f32_16x16x32_bf16 v[60:63], v[100:103], v[124:127], 0
    ds_read_b128 v[144:147], v193 offset:16384
    v_mfma_f32_16x16x32_bf16 v[56:59], v[100:103], v[120:123], 0
    ds_read_b128 v[148:151], v193 offset:18432
    buffer_load_dwordx4 v8, s[20:23], s74 offen offset:2048 lds
    v_mfma_f32_16x16x32_bf16 v[52:55], v[100:103], v[116:119], 0
    ds_read_b128 v[152:155], v193 offset:20480
    v_mfma_f32_16x16x32_bf16 v[48:51], v[100:103], v[112:115], 0
    ds_read_b128 v[156:159], v193 offset:22528
    s_waitcnt lgkmcnt(8)
    v_mfma_f32_16x16x32_bf16 v[64:67], v[104:107], v[112:115], 0
    ds_read_b64_tr_b16 v[132:133], v199 offset:8192
    buffer_load_dwordx4 v9, s[20:23], s74 offen offset:3072 lds
    v_mfma_f32_16x16x32_bf16 v[68:71], v[104:107], v[116:119], 0
    ds_read_b64_tr_b16 v[134:135], v199 offset:9216
    v_mfma_f32_16x16x32_bf16 v[72:75], v[104:107], v[120:123], 0
    ds_read_b64_tr_b16 v[136:137], v200 offset:8192
    v_mfma_f32_16x16x32_bf16 v[76:79], v[104:107], v[124:127], 0
    ds_read_b64_tr_b16 v[138:139], v200 offset:9216
    s_waitcnt lgkmcnt(10)
    v_mfma_f32_16x16x32_bf16 v[92:95], v[108:111], v[124:127], 0
    ds_read_b64_tr_b16 v[140:141], v201 offset:8192
    v_mfma_f32_16x16x32_bf16 v[88:91], v[108:111], v[120:123], 0
    ds_read_b64_tr_b16 v[142:143], v201 offset:9216
    s_add_u32 m0, s47, 81920
    v_mfma_f32_16x16x32_bf16 v[84:87], v[108:111], v[116:119], 0
    buffer_load_dwordx4 v2, s[16:19], s66 offen offset:0 lds
    v_mfma_f32_16x16x32_bf16 v[80:83], v[108:111], v[112:115], 0
    s_waitcnt lgkmcnt(6)
    v_mfma_f32_16x16x32_bf16 v[32:35], v[128:131], v[144:147], v[32:35]
    buffer_load_dwordx4 v3, s[16:19], s66 offen offset:1024 lds
    v_mfma_f32_16x16x32_bf16 v[36:39], v[128:131], v[148:151], v[36:39]
    v_mfma_f32_16x16x32_bf16 v[40:43], v[128:131], v[152:155], v[40:43]
    buffer_load_dwordx4 v4, s[16:19], s66 offen offset:2048 lds
    v_mfma_f32_16x16x32_bf16 v[44:47], v[128:131], v[156:159], v[44:47]
    s_waitcnt lgkmcnt(4)
    v_mfma_f32_16x16x32_bf16 v[60:63], v[132:135], v[156:159], v[60:63]
    buffer_load_dwordx4 v5, s[16:19], s66 offen offset:3072 lds
    v_mfma_f32_16x16x32_bf16 v[56:59], v[132:135], v[152:155], v[56:59]
    v_mfma_f32_16x16x32_bf16 v[52:55], v[132:135], v[148:151], v[52:55]
    v_mfma_f32_16x16x32_bf16 v[48:51], v[132:135], v[144:147], v[48:51]
    s_waitcnt vmcnt(8) lgkmcnt(0)
    s_barrier
    v_mfma_f32_16x16x32_bf16 v[64:67], v[136:139], v[144:147], v[64:67]
    ds_read_b64_tr_b16 v[96:97], v198 offset:32768
    ds_read_b64_tr_b16 v[98:99], v198 offset:33792
    v_mfma_f32_16x16x32_bf16 v[68:71], v[136:139], v[148:151], v[68:71]
    ds_read_b128 v[112:115], v192 offset:49152
    ds_read_b128 v[116:119], v192 offset:51200
    v_mfma_f32_16x16x32_bf16 v[72:75], v[136:139], v[152:155], v[72:75]
    ds_read_b128 v[120:123], v192 offset:53248
    ds_read_b128 v[124:127], v192 offset:55296
    v_mfma_f32_16x16x32_bf16 v[76:79], v[136:139], v[156:159], v[76:79]
    ds_read_b64_tr_b16 v[100:101], v199 offset:32768
    v_mfma_f32_16x16x32_bf16 v[92:95], v[140:143], v[156:159], v[92:95]
    ds_read_b64_tr_b16 v[102:103], v199 offset:33792
    v_mfma_f32_16x16x32_bf16 v[88:91], v[140:143], v[152:155], v[88:91]
    ds_read_b64_tr_b16 v[104:105], v200 offset:32768
    v_mfma_f32_16x16x32_bf16 v[84:87], v[140:143], v[148:151], v[84:87]
    ds_read_b64_tr_b16 v[106:107], v200 offset:33792
    s_add_u32 m0, s47, 98304
    v_mfma_f32_16x16x32_bf16 v[80:83], v[140:143], v[144:147], v[80:83]
    buffer_load_dwordx4 v6, s[20:23], s75 offen offset:0 lds
    s_waitcnt lgkmcnt(4)
    v_mfma_f32_16x16x32_bf16 v[32:35], v[96:99], v[112:115], v[32:35]
    ds_read_b64_tr_b16 v[108:109], v201 offset:32768
    v_mfma_f32_16x16x32_bf16 v[36:39], v[96:99], v[116:119], v[36:39]
    ds_read_b64_tr_b16 v[110:111], v201 offset:33792
    v_mfma_f32_16x16x32_bf16 v[40:43], v[96:99], v[120:123], v[40:43]
    ds_read_b64_tr_b16 v[128:129], v198 offset:40960
    buffer_load_dwordx4 v7, s[20:23], s75 offen offset:1024 lds
    v_mfma_f32_16x16x32_bf16 v[44:47], v[96:99], v[124:127], v[44:47]
    ds_read_b64_tr_b16 v[130:131], v198 offset:41984
    s_waitcnt lgkmcnt(6)
    v_mfma_f32_16x16x32_bf16 v[60:63], v[100:103], v[124:127], v[60:63]
    ds_read_b128 v[144:147], v193 offset:49152
    v_mfma_f32_16x16x32_bf16 v[56:59], v[100:103], v[120:123], v[56:59]
    ds_read_b128 v[148:151], v193 offset:51200
    buffer_load_dwordx4 v8, s[20:23], s75 offen offset:2048 lds
    v_mfma_f32_16x16x32_bf16 v[52:55], v[100:103], v[116:119], v[52:55]
    ds_read_b128 v[152:155], v193 offset:53248
    v_mfma_f32_16x16x32_bf16 v[48:51], v[100:103], v[112:115], v[48:51]
    ds_read_b128 v[156:159], v193 offset:55296
    s_waitcnt lgkmcnt(8)
    v_mfma_f32_16x16x32_bf16 v[64:67], v[104:107], v[112:115], v[64:67]
    ds_read_b64_tr_b16 v[132:133], v199 offset:40960
    buffer_load_dwordx4 v9, s[20:23], s75 offen offset:3072 lds
    v_mfma_f32_16x16x32_bf16 v[68:71], v[104:107], v[116:119], v[68:71]
    ds_read_b64_tr_b16 v[134:135], v199 offset:41984
    v_mfma_f32_16x16x32_bf16 v[72:75], v[104:107], v[120:123], v[72:75]
    ds_read_b64_tr_b16 v[136:137], v200 offset:40960
    v_mfma_f32_16x16x32_bf16 v[76:79], v[104:107], v[124:127], v[76:79]
    ds_read_b64_tr_b16 v[138:139], v200 offset:41984
    s_waitcnt lgkmcnt(10)
    v_mfma_f32_16x16x32_bf16 v[92:95], v[108:111], v[124:127], v[92:95]
    ds_read_b64_tr_b16 v[140:141], v201 offset:40960
    v_mfma_f32_16x16x32_bf16 v[88:91], v[108:111], v[120:123], v[88:91]
    ds_read_b64_tr_b16 v[142:143], v201 offset:41984
    s_add_u32 m0, s47, 114688
    v_mfma_f32_16x16x32_bf16 v[84:87], v[108:111], v[116:119], v[84:87]
    buffer_load_dwordx4 v2, s[16:19], s67 offen offset:0 lds
    v_mfma_f32_16x16x32_bf16 v[80:83], v[108:111], v[112:115], v[80:83]
    s_waitcnt lgkmcnt(6)
    v_mfma_f32_16x16x32_bf16 v[32:35], v[128:131], v[144:147], v[32:35]
    buffer_load_dwordx4 v3, s[16:19], s67 offen offset:1024 lds
    v_mfma_f32_16x16x32_bf16 v[36:39], v[128:131], v[148:151], v[36:39]
    v_mfma_f32_16x16x32_bf16 v[40:43], v[128:131], v[152:155], v[40:43]
    buffer_load_dwordx4 v4, s[16:19], s67 offen offset:2048 lds
    v_mfma_f32_16x16x32_bf16 v[44:47], v[128:131], v[156:159], v[44:47]
    s_waitcnt lgkmcnt(4)
    v_mfma_f32_16x16x32_bf16 v[60:63], v[132:135], v[156:159], v[60:63]
    buffer_load_dwordx4 v5, s[16:19], s67 offen offset:3072 lds
    v_mfma_f32_16x16x32_bf16 v[56:59], v[132:135], v[152:155], v[56:59]
    v_mfma_f32_16x16x32_bf16 v[52:55], v[132:135], v[148:151], v[52:55]
    v_mfma_f32_16x16x32_bf16 v[48:51], v[132:135], v[144:147], v[48:51]
    s_waitcnt vmcnt(8) lgkmcnt(0)
    s_barrier
    v_mfma_f32_16x16x32_bf16 v[64:67], v[136:139], v[144:147], v[64:67]
    ds_read_b64_tr_b16 v[96:97], v202 offset:0
    ds_read_b64_tr_b16 v[98:99], v202 offset:1024
    v_mfma_f32_16x16x32_bf16 v[68:71], v[136:139], v[148:151], v[68:71]
    ds_read_b128 v[112:115], v194 offset:16384
    ds_read_b128 v[116:119], v194 offset:18432
    v_mfma_f32_16x16x32_bf16 v[72:75], v[136:139], v[152:155], v[72:75]
    ds_read_b128 v[120:123], v194 offset:20480
    ds_read_b128 v[124:127], v194 offset:22528
    v_mfma_f32_16x16x32_bf16 v[76:79], v[136:139], v[156:159], v[76:79]
    ds_read_b64_tr_b16 v[100:101], v203 offset:0
    v_mfma_f32_16x16x32_bf16 v[92:95], v[140:143], v[156:159], v[92:95]
    ds_read_b64_tr_b16 v[102:103], v203 offset:1024
    v_mfma_f32_16x16x32_bf16 v[88:91], v[140:143], v[152:155], v[88:91]
    ds_read_b64_tr_b16 v[104:105], v204 offset:0
    v_mfma_f32_16x16x32_bf16 v[84:87], v[140:143], v[148:151], v[84:87]
    ds_read_b64_tr_b16 v[106:107], v204 offset:1024
    s_add_u32 m0, s55, 131072
    v_mfma_f32_16x16x32_bf16 v[80:83], v[140:143], v[144:147], v[80:83]
    buffer_load_dwordx4 v10, s[24:27], s56 offen offset:0 lds
    s_waitcnt lgkmcnt(4)
    v_mfma_f32_16x16x32_bf16 v[32:35], v[96:99], v[112:115], v[32:35]
    ds_read_b64_tr_b16 v[108:109], v205 offset:0
    v_mfma_f32_16x16x32_bf16 v[36:39], v[96:99], v[116:119], v[36:39]
    ds_read_b64_tr_b16 v[110:111], v205 offset:1024
    v_mfma_f32_16x16x32_bf16 v[40:43], v[96:99], v[120:123], v[40:43]
    ds_read_b64_tr_b16 v[128:129], v202 offset:8192
    buffer_load_dwordx4 v11, s[24:27], s56 offen offset:1024 lds
    v_mfma_f32_16x16x32_bf16 v[44:47], v[96:99], v[124:127], v[44:47]
    ds_read_b64_tr_b16 v[130:131], v202 offset:9216
    s_waitcnt lgkmcnt(6)
    v_mfma_f32_16x16x32_bf16 v[60:63], v[100:103], v[124:127], v[60:63]
    ds_read_b128 v[144:147], v195 offset:16384
    v_mfma_f32_16x16x32_bf16 v[56:59], v[100:103], v[120:123], v[56:59]
    ds_read_b128 v[148:151], v195 offset:18432
    buffer_load_dwordx4 v12, s[24:27], s56 offen offset:2048 lds
    v_mfma_f32_16x16x32_bf16 v[52:55], v[100:103], v[116:119], v[52:55]
    ds_read_b128 v[152:155], v195 offset:20480
    v_mfma_f32_16x16x32_bf16 v[48:51], v[100:103], v[112:115], v[48:51]
    ds_read_b128 v[156:159], v195 offset:22528
    s_waitcnt lgkmcnt(8)
    v_mfma_f32_16x16x32_bf16 v[64:67], v[104:107], v[112:115], v[64:67]
    ds_read_b64_tr_b16 v[132:133], v203 offset:8192
    buffer_load_dwordx4 v13, s[24:27], s56 offen offset:3072 lds
    v_mfma_f32_16x16x32_bf16 v[68:71], v[104:107], v[116:119], v[68:71]
    ds_read_b64_tr_b16 v[134:135], v203 offset:9216
    v_mfma_f32_16x16x32_bf16 v[72:75], v[104:107], v[120:123], v[72:75]
    ds_read_b64_tr_b16 v[136:137], v204 offset:8192
    v_mfma_f32_16x16x32_bf16 v[76:79], v[104:107], v[124:127], v[76:79]
    ds_read_b64_tr_b16 v[138:139], v204 offset:9216
    s_waitcnt lgkmcnt(10)
    v_mfma_f32_16x16x32_bf16 v[92:95], v[108:111], v[124:127], v[92:95]
    ds_read_b64_tr_b16 v[140:141], v205 offset:8192
    v_mfma_f32_16x16x32_bf16 v[88:91], v[108:111], v[120:123], v[88:91]
    ds_read_b64_tr_b16 v[142:143], v205 offset:9216
    s_add_u32 m0, s55, 135168
    s_add_u32 s46, s56, 32768
    v_mfma_f32_16x16x32_bf16 v[84:87], v[108:111], v[116:119], v[84:87]
    buffer_load_dwordx4 v10, s[24:27], s46 offen offset:0 lds
    v_mfma_f32_16x16x32_bf16 v[80:83], v[108:111], v[112:115], v[80:83]
    s_waitcnt lgkmcnt(6)
    v_mfma_f32_16x16x32_bf16 v[32:35], v[128:131], v[144:147], v[32:35]
    buffer_load_dwordx4 v11, s[24:27], s46 offen offset:1024 lds
    v_mfma_f32_16x16x32_bf16 v[36:39], v[128:131], v[148:151], v[36:39]
    v_mfma_f32_16x16x32_bf16 v[40:43], v[128:131], v[152:155], v[40:43]
    buffer_load_dwordx4 v12, s[24:27], s46 offen offset:2048 lds
    v_mfma_f32_16x16x32_bf16 v[44:47], v[128:131], v[156:159], v[44:47]
    s_waitcnt lgkmcnt(4)
    v_mfma_f32_16x16x32_bf16 v[60:63], v[132:135], v[156:159], v[60:63]
    buffer_load_dwordx4 v13, s[24:27], s46 offen offset:3072 lds
    v_mfma_f32_16x16x32_bf16 v[56:59], v[132:135], v[152:155], v[56:59]
    v_mfma_f32_16x16x32_bf16 v[52:55], v[132:135], v[148:151], v[52:55]
    v_mfma_f32_16x16x32_bf16 v[48:51], v[132:135], v[144:147], v[48:51]
    buffer_load_dwordx2 v[20:21], v18, s[32:35], 0 offen sc1
    s_waitcnt vmcnt(9) lgkmcnt(0)
    s_barrier
    v_mfma_f32_16x16x32_bf16 v[64:67], v[136:139], v[144:147], v[64:67]
    ds_read_b64_tr_b16 v[96:97], v202 offset:32768
    ds_read_b64_tr_b16 v[98:99], v202 offset:33792
    v_mfma_f32_16x16x32_bf16 v[68:71], v[136:139], v[148:151], v[68:71]
    ds_read_b128 v[112:115], v194 offset:49152
    ds_read_b128 v[116:119], v194 offset:51200
    v_mfma_f32_16x16x32_bf16 v[72:75], v[136:139], v[152:155], v[72:75]
    ds_read_b128 v[120:123], v194 offset:53248
    ds_read_b128 v[124:127], v194 offset:55296
    v_mfma_f32_16x16x32_bf16 v[76:79], v[136:139], v[156:159], v[76:79]
    ds_read_b64_tr_b16 v[100:101], v203 offset:32768
    v_mfma_f32_16x16x32_bf16 v[92:95], v[140:143], v[156:159], v[92:95]
    ds_read_b64_tr_b16 v[102:103], v203 offset:33792
    v_mfma_f32_16x16x32_bf16 v[88:91], v[140:143], v[152:155], v[88:91]
    ds_read_b64_tr_b16 v[104:105], v204 offset:32768
    v_mfma_f32_16x16x32_bf16 v[84:87], v[140:143], v[148:151], v[84:87]
    ds_read_b64_tr_b16 v[106:107], v204 offset:33792
    s_add_u32 m0, s47, 0
    v_mfma_f32_16x16x32_bf16 v[80:83], v[140:143], v[144:147], v[80:83]
    buffer_load_dwordx4 v6, s[20:23], s76 offen offset:0 lds
    s_waitcnt lgkmcnt(4)
    v_mfma_f32_16x16x32_bf16 v[32:35], v[96:99], v[112:115], v[32:35]
    ds_read_b64_tr_b16 v[108:109], v205 offset:32768
    v_mfma_f32_16x16x32_bf16 v[36:39], v[96:99], v[116:119], v[36:39]
    ds_read_b64_tr_b16 v[110:111], v205 offset:33792
    v_mfma_f32_16x16x32_bf16 v[40:43], v[96:99], v[120:123], v[40:43]
    ds_read_b64_tr_b16 v[128:129], v202 offset:40960
    buffer_load_dwordx4 v7, s[20:23], s76 offen offset:1024 lds
    v_mfma_f32_16x16x32_bf16 v[44:47], v[96:99], v[124:127], v[44:47]
    ds_read_b64_tr_b16 v[130:131], v202 offset:41984
    s_waitcnt lgkmcnt(6)
    v_mfma_f32_16x16x32_bf16 v[60:63], v[100:103], v[124:127], v[60:63]
    ds_read_b128 v[144:147], v195 offset:49152
    v_mfma_f32_16x16x32_bf16 v[56:59], v[100:103], v[120:123], v[56:59]
    ds_read_b128 v[148:151], v195 offset:51200
    buffer_load_dwordx4 v8, s[20:23], s76 offen offset:2048 lds
    v_mfma_f32_16x16x32_bf16 v[52:55], v[100:103], v[116:119], v[52:55]
    ds_read_b128 v[152:155], v195 offset:53248
    v_mfma_f32_16x16x32_bf16 v[48:51], v[100:103], v[112:115], v[48:51]
    ds_read_b128 v[156:159], v195 offset:55296
    s_waitcnt lgkmcnt(8)
    v_mfma_f32_16x16x32_bf16 v[64:67], v[104:107], v[112:115], v[64:67]
    ds_read_b64_tr_b16 v[132:133], v203 offset:40960
    buffer_load_dwordx4 v9, s[20:23], s76 offen offset:3072 lds
    v_mfma_f32_16x16x32_bf16 v[68:71], v[104:107], v[116:119], v[68:71]
    ds_read_b64_tr_b16 v[134:135], v203 offset:41984
    v_mfma_f32_16x16x32_bf16 v[72:75], v[104:107], v[120:123], v[72:75]
    ds_read_b64_tr_b16 v[136:137], v204 offset:40960
    v_mfma_f32_16x16x32_bf16 v[76:79], v[104:107], v[124:127], v[76:79]
    ds_read_b64_tr_b16 v[138:139], v204 offset:41984
    s_waitcnt lgkmcnt(10)
    v_mfma_f32_16x16x32_bf16 v[92:95], v[108:111], v[124:127], v[92:95]
    ds_read_b64_tr_b16 v[140:141], v205 offset:40960
    v_mfma_f32_16x16x32_bf16 v[88:91], v[108:111], v[120:123], v[88:91]
    ds_read_b64_tr_b16 v[142:143], v205 offset:41984
    s_add_u32 m0, s47, 16384
    v_mfma_f32_16x16x32_bf16 v[84:87], v[108:111], v[116:119], v[84:87]
    buffer_load_dwordx4 v2, s[16:19], s68 offen offset:0 lds
    v_mfma_f32_16x16x32_bf16 v[80:83], v[108:111], v[112:115], v[80:83]
    s_waitcnt lgkmcnt(6)
    v_mfma_f32_16x16x32_bf16 v[32:35], v[128:131], v[144:147], v[32:35]
    buffer_load_dwordx4 v3, s[16:19], s68 offen offset:1024 lds
    v_mfma_f32_16x16x32_bf16 v[36:39], v[128:131], v[148:151], v[36:39]
    v_mfma_f32_16x16x32_bf16 v[40:43], v[128:131], v[152:155], v[40:43]
    buffer_load_dwordx4 v4, s[16:19], s68 offen offset:2048 lds
    v_mfma_f32_16x16x32_bf16 v[44:47], v[128:131], v[156:159], v[44:47]
    s_waitcnt lgkmcnt(4)
    v_mfma_f32_16x16x32_bf16 v[60:63], v[132:135], v[156:159], v[60:63]
    buffer_load_dwordx4 v5, s[16:19], s68 offen offset:3072 lds
    v_mfma_f32_16x16x32_bf16 v[56:59], v[132:135], v[152:155], v[56:59]
    v_mfma_f32_16x16x32_bf16 v[52:55], v[132:135], v[148:151], v[52:55]
    v_mfma_f32_16x16x32_bf16 v[48:51], v[132:135], v[144:147], v[48:51]
    s_waitcnt vmcnt(8) lgkmcnt(0)
    s_barrier
    v_mfma_f32_16x16x32_bf16 v[64:67], v[136:139], v[144:147], v[64:67]
    ds_read_b64_tr_b16 a[0:1], v218 offset:0
    ds_read_b64_tr_b16 a[2:3], v218 offset:2048
    v_mfma_f32_16x16x32_bf16 v[68:71], v[136:139], v[148:151], v[68:71]
    ds_read_b64_tr_b16 a[4:5], v219 offset:0
    ds_read_b64_tr_b16 a[6:7], v219 offset:2048
    v_mfma_f32_16x16x32_bf16 v[72:75], v[136:139], v[152:155], v[72:75]
    ds_read_b64_tr_b16 a[8:9], v220 offset:0
    ds_read_b64_tr_b16 a[10:11], v220 offset:2048
    v_mfma_f32_16x16x32_bf16 v[76:79], v[136:139], v[156:159], v[76:79]
    ds_read_b64_tr_b16 a[12:13], v221 offset:0
    ds_read_b64_tr_b16 a[14:15], v221 offset:2048
    v_mfma_f32_16x16x32_bf16 v[92:95], v[140:143], v[156:159], v[92:95]
    ds_read_b64_tr_b16 a[16:17], v218 offset:4096
    ds_read_b64_tr_b16 a[18:19], v218 offset:6144
    v_mfma_f32_16x16x32_bf16 v[88:91], v[140:143], v[152:155], v[88:91]
    ds_read_b64_tr_b16 a[20:21], v219 offset:4096
    ds_read_b64_tr_b16 a[22:23], v219 offset:6144
    v_mfma_f32_16x16x32_bf16 v[84:87], v[140:143], v[148:151], v[84:87]
    v_mfma_f32_16x16x32_bf16 v[80:83], v[140:143], v[144:147], v[80:83]
    s_waitcnt lgkmcnt(4)
    ds_read_b64_tr_b16 a[24:25], v220 offset:4096
    ds_read_b64_tr_b16 a[26:27], v220 offset:6144
    ds_read_b64_tr_b16 a[28:29], v221 offset:4096
    ds_read_b64_tr_b16 a[30:31], v221 offset:6144
    s_add_u32 m0, s47, 32768
    s_nop 0
    buffer_load_dwordx4 v6, s[20:23], s77 offen offset:0 lds
    buffer_load_dwordx4 v7, s[20:23], s77 offen offset:1024 lds
    buffer_load_dwordx4 v8, s[20:23], s77 offen offset:2048 lds
    buffer_load_dwordx4 v9, s[20:23], s77 offen offset:3072 lds
    s_add_u32 m0, s47, 49152
    s_nop 0
    buffer_load_dwordx4 v2, s[16:19], s69 offen offset:0 lds
    buffer_load_dwordx4 v3, s[16:19], s69 offen offset:1024 lds
    buffer_load_dwordx4 v4, s[16:19], s69 offen offset:2048 lds
    buffer_load_dwordx4 v5, s[16:19], s69 offen offset:3072 lds
    s_waitcnt vmcnt(8) lgkmcnt(0)
    s_barrier
    ds_read_b64_tr_b16 v[96:97], v198 offset:0
    ds_read_b64_tr_b16 v[98:99], v198 offset:1024
    ds_read_b128 v[112:115], v192 offset:16384
    ds_read_b128 v[116:119], v192 offset:18432
    ds_read_b128 v[120:123], v192 offset:20480
    ds_read_b128 v[124:127], v192 offset:22528
    ds_read_b64_tr_b16 v[100:101], v199 offset:0
    ds_read_b64_tr_b16 v[102:103], v199 offset:1024
    ds_read_b64_tr_b16 v[104:105], v200 offset:0
    ds_read_b64_tr_b16 v[106:107], v200 offset:1024
    s_add_u32 m0, s47, 65536
    s_nop 0
    buffer_load_dwordx4 v6, s[20:23], s78 offen offset:0 lds
    s_waitcnt lgkmcnt(4)
    v_mfma_f32_16x16x32_bf16 v[32:35], v[96:99], v[112:115], v[32:35]
    ds_read_b64_tr_b16 v[108:109], v201 offset:0
    v_mfma_f32_16x16x32_bf16 v[36:39], v[96:99], v[116:119], v[36:39]
    ds_read_b64_tr_b16 v[110:111], v201 offset:1024
    v_mfma_f32_16x16x32_bf16 v[40:43], v[96:99], v[120:123], v[40:43]
    ds_read_b64_tr_b16 v[128:129], v198 offset:8192
    buffer_load_dwordx4 v7, s[20:23], s78 offen offset:1024 lds
    v_mfma_f32_16x16x32_bf16 v[44:47], v[96:99], v[124:127], v[44:47]
    ds_read_b64_tr_b16 v[130:131], v198 offset:9216
    s_waitcnt lgkmcnt(6)
    v_mfma_f32_16x16x32_bf16 v[60:63], v[100:103], v[124:127], v[60:63]
    ds_read_b128 v[144:147], v193 offset:16384
    v_mfma_f32_16x16x32_bf16 v[56:59], v[100:103], v[120:123], v[56:59]
    ds_read_b128 v[148:151], v193 offset:18432
    buffer_load_dwordx4 v8, s[20:23], s78 offen offset:2048 lds
    v_mfma_f32_16x16x32_bf16 v[52:55], v[100:103], v[116:119], v[52:55]
    ds_read_b128 v[152:155], v193 offset:20480
    v_mfma_f32_16x16x32_bf16 v[48:51], v[100:103], v[112:115], v[48:51]
    ds_read_b128 v[156:159], v193 offset:22528
    s_waitcnt lgkmcnt(8)
    v_mfma_f32_16x16x32_bf16 v[64:67], v[104:107], v[112:115], v[64:67]
    ds_read_b64_tr_b16 v[132:133], v199 offset:8192
    buffer_load_dwordx4 v9, s[20:23], s78 offen offset:3072 lds
    v_mfma_f32_16x16x32_bf16 v[68:71], v[104:107], v[116:119], v[68:71]
    ds_read_b64_tr_b16 v[134:135], v199 offset:9216
    v_mfma_f32_16x16x32_bf16 v[72:75], v[104:107], v[120:123], v[72:75]
    ds_read_b64_tr_b16 v[136:137], v200 offset:8192
    v_mfma_f32_16x16x32_bf16 v[76:79], v[104:107], v[124:127], v[76:79]
    ds_read_b64_tr_b16 v[138:139], v200 offset:9216
    s_waitcnt lgkmcnt(10)
    v_mfma_f32_16x16x32_bf16 v[92:95], v[108:111], v[124:127], v[92:95]
    ds_read_b64_tr_b16 v[140:141], v201 offset:8192
    v_mfma_f32_16x16x32_bf16 v[88:91], v[108:111], v[120:123], v[88:91]
    ds_read_b64_tr_b16 v[142:143], v201 offset:9216
    s_add_u32 m0, s47, 81920
    v_mfma_f32_16x16x32_bf16 v[84:87], v[108:111], v[116:119], v[84:87]
    buffer_load_dwordx4 v2, s[16:19], s70 offen offset:0 lds
    v_mfma_f32_16x16x32_bf16 v[80:83], v[108:111], v[112:115], v[80:83]
    s_waitcnt lgkmcnt(6)
    v_mfma_f32_16x16x32_bf16 v[32:35], v[128:131], v[144:147], v[32:35]
    buffer_load_dwordx4 v3, s[16:19], s70 offen offset:1024 lds
    v_mfma_f32_16x16x32_bf16 v[36:39], v[128:131], v[148:151], v[36:39]
    v_mfma_f32_16x16x32_bf16 v[40:43], v[128:131], v[152:155], v[40:43]
    buffer_load_dwordx4 v4, s[16:19], s70 offen offset:2048 lds
    v_mfma_f32_16x16x32_bf16 v[44:47], v[128:131], v[156:159], v[44:47]
    s_waitcnt lgkmcnt(4)
    v_mfma_f32_16x16x32_bf16 v[60:63], v[132:135], v[156:159], v[60:63]
    buffer_load_dwordx4 v5, s[16:19], s70 offen offset:3072 lds
    v_mfma_f32_16x16x32_bf16 v[56:59], v[132:135], v[152:155], v[56:59]
    v_mfma_f32_16x16x32_bf16 v[52:55], v[132:135], v[148:151], v[52:55]
    v_mfma_f32_16x16x32_bf16 v[48:51], v[132:135], v[144:147], v[48:51]
    s_waitcnt vmcnt(8) lgkmcnt(0)
    s_barrier
    v_mfma_f32_16x16x32_bf16 v[64:67], v[136:139], v[144:147], v[64:67]
    ds_read_b64_tr_b16 v[96:97], v198 offset:32768
    ds_read_b64_tr_b16 v[98:99], v198 offset:33792
    v_mfma_f32_16x16x32_bf16 v[68:71], v[136:139], v[148:151], v[68:71]
    ds_read_b128 v[112:115], v192 offset:49152
    ds_read_b128 v[116:119], v192 offset:51200
    v_mfma_f32_16x16x32_bf16 v[72:75], v[136:139], v[152:155], v[72:75]
    ds_read_b128 v[120:123], v192 offset:53248
    ds_read_b128 v[124:127], v192 offset:55296
    v_mfma_f32_16x16x32_bf16 v[76:79], v[136:139], v[156:159], v[76:79]
    ds_read_b64_tr_b16 v[100:101], v199 offset:32768
    v_mfma_f32_16x16x32_bf16 v[92:95], v[140:143], v[156:159], v[92:95]
    ds_read_b64_tr_b16 v[102:103], v199 offset:33792
    v_mfma_f32_16x16x32_bf16 v[88:91], v[140:143], v[152:155], v[88:91]
    ds_read_b64_tr_b16 v[104:105], v200 offset:32768
    v_mfma_f32_16x16x32_bf16 v[84:87], v[140:143], v[148:151], v[84:87]
    ds_read_b64_tr_b16 v[106:107], v200 offset:33792
    s_add_u32 m0, s47, 98304
    v_mfma_f32_16x16x32_bf16 v[80:83], v[140:143], v[144:147], v[80:83]
    buffer_load_dwordx4 v6, s[20:23], s79 offen offset:0 lds
    s_waitcnt lgkmcnt(4)
    v_mfma_f32_16x16x32_bf16 v[32:35], v[96:99], v[112:115], v[32:35]
    ds_read_b64_tr_b16 v[108:109], v201 offset:32768
    v_mfma_f32_16x16x32_bf16 v[36:39], v[96:99], v[116:119], v[36:39]
    ds_read_b64_tr_b16 v[110:111], v201 offset:33792
    v_mfma_f32_16x16x32_bf16 v[40:43], v[96:99], v[120:123], v[40:43]
    ds_read_b64_tr_b16 v[128:129], v198 offset:40960
    buffer_load_dwordx4 v7, s[20:23], s79 offen offset:1024 lds
    v_mfma_f32_16x16x32_bf16 v[44:47], v[96:99], v[124:127], v[44:47]
    ds_read_b64_tr_b16 v[130:131], v198 offset:41984
    s_waitcnt lgkmcnt(6)
    v_mfma_f32_16x16x32_bf16 v[60:63], v[100:103], v[124:127], v[60:63]
    ds_read_b128 v[144:147], v193 offset:49152
    v_mfma_f32_16x16x32_bf16 v[56:59], v[100:103], v[120:123], v[56:59]
    ds_read_b128 v[148:151], v193 offset:51200
    buffer_load_dwordx4 v8, s[20:23], s79 offen offset:2048 lds
    v_mfma_f32_16x16x32_bf16 v[52:55], v[100:103], v[116:119], v[52:55]
    ds_read_b128 v[152:155], v193 offset:53248
    v_mfma_f32_16x16x32_bf16 v[48:51], v[100:103], v[112:115], v[48:51]
    ds_read_b128 v[156:159], v193 offset:55296
    s_waitcnt lgkmcnt(8)
    v_mfma_f32_16x16x32_bf16 v[64:67], v[104:107], v[112:115], v[64:67]
    ds_read_b64_tr_b16 v[132:133], v199 offset:40960
    buffer_load_dwordx4 v9, s[20:23], s79 offen offset:3072 lds
    v_mfma_f32_16x16x32_bf16 v[68:71], v[104:107], v[116:119], v[68:71]
    ds_read_b64_tr_b16 v[134:135], v199 offset:41984
    v_mfma_f32_16x16x32_bf16 v[72:75], v[104:107], v[120:123], v[72:75]
    ds_read_b64_tr_b16 v[136:137], v200 offset:40960
    v_mfma_f32_16x16x32_bf16 v[76:79], v[104:107], v[124:127], v[76:79]
    ds_read_b64_tr_b16 v[138:139], v200 offset:41984
    s_waitcnt lgkmcnt(10)
    v_mfma_f32_16x16x32_bf16 v[92:95], v[108:111], v[124:127], v[92:95]
    ds_read_b64_tr_b16 v[140:141], v201 offset:40960
    v_mfma_f32_16x16x32_bf16 v[88:91], v[108:111], v[120:123], v[88:91]
    ds_read_b64_tr_b16 v[142:143], v201 offset:41984
    s_add_u32 m0, s47, 114688
    v_mfma_f32_16x16x32_bf16 v[84:87], v[108:111], v[116:119], v[84:87]
    buffer_load_dwordx4 v2, s[16:19], s71 offen offset:0 lds
    v_mfma_f32_16x16x32_bf16 v[80:83], v[108:111], v[112:115], v[80:83]
    s_waitcnt lgkmcnt(6)
    v_mfma_f32_16x16x32_bf16 v[32:35], v[128:131], v[144:147], v[32:35]
    buffer_load_dwordx4 v3, s[16:19], s71 offen offset:1024 lds
    v_mfma_f32_16x16x32_bf16 v[36:39], v[128:131], v[148:151], v[36:39]
    v_mfma_f32_16x16x32_bf16 v[40:43], v[128:131], v[152:155], v[40:43]
    buffer_load_dwordx4 v4, s[16:19], s71 offen offset:2048 lds
    v_mfma_f32_16x16x32_bf16 v[44:47], v[128:131], v[156:159], v[44:47]
    s_waitcnt lgkmcnt(4)
    v_mfma_f32_16x16x32_bf16 v[60:63], v[132:135], v[156:159], v[60:63]
    buffer_load_dwordx4 v5, s[16:19], s71 offen offset:3072 lds
    v_mfma_f32_16x16x32_bf16 v[56:59], v[132:135], v[152:155], v[56:59]
    v_mfma_f32_16x16x32_bf16 v[52:55], v[132:135], v[148:151], v[52:55]
    v_mfma_f32_16x16x32_bf16 v[48:51], v[132:135], v[144:147], v[48:51]
    s_waitcnt vmcnt(8) lgkmcnt(0)
    s_barrier
    v_mfma_f32_16x16x32_bf16 v[64:67], v[136:139], v[144:147], v[64:67]
    ds_read_b64_tr_b16 v[96:97], v202 offset:0
    ds_read_b64_tr_b16 v[98:99], v202 offset:1024
    v_mfma_f32_16x16x32_bf16 v[68:71], v[136:139], v[148:151], v[68:71]
    ds_read_b128 v[112:115], v194 offset:16384
    ds_read_b128 v[116:119], v194 offset:18432
    v_mfma_f32_16x16x32_bf16 v[72:75], v[136:139], v[152:155], v[72:75]
    ds_read_b128 v[120:123], v194 offset:20480
    ds_read_b128 v[124:127], v194 offset:22528
    v_mfma_f32_16x16x32_bf16 v[76:79], v[136:139], v[156:159], v[76:79]
    ds_read_b64_tr_b16 v[100:101], v203 offset:0
    v_mfma_f32_16x16x32_bf16 v[92:95], v[140:143], v[156:159], v[92:95]
    ds_read_b64_tr_b16 v[102:103], v203 offset:1024
    v_mfma_f32_16x16x32_bf16 v[88:91], v[140:143], v[152:155], v[88:91]
    ds_read_b64_tr_b16 v[104:105], v204 offset:0
    v_mfma_f32_16x16x32_bf16 v[84:87], v[140:143], v[148:151], v[84:87]
    ds_read_b64_tr_b16 v[106:107], v204 offset:1024
    s_add_u32 m0, s55, 131072
    v_mfma_f32_16x16x32_bf16 v[80:83], v[140:143], v[144:147], v[80:83]
    buffer_load_dwordx4 v10, s[24:27], s61 offen offset:0 lds
    s_waitcnt lgkmcnt(4)
    v_mfma_f32_16x16x32_bf16 v[32:35], v[96:99], v[112:115], v[32:35]
    ds_read_b64_tr_b16 v[108:109], v205 offset:0
    v_mfma_f32_16x16x32_bf16 v[36:39], v[96:99], v[116:119], v[36:39]
    ds_read_b64_tr_b16 v[110:111], v205 offset:1024
    v_mfma_f32_16x16x32_bf16 v[40:43], v[96:99], v[120:123], v[40:43]
    ds_read_b64_tr_b16 v[128:129], v202 offset:8192
    buffer_load_dwordx4 v11, s[24:27], s61 offen offset:1024 lds
    v_mfma_f32_16x16x32_bf16 v[44:47], v[96:99], v[124:127], v[44:47]
    ds_read_b64_tr_b16 v[130:131], v202 offset:9216
    s_waitcnt lgkmcnt(6)
    v_mfma_f32_16x16x32_bf16 v[60:63], v[100:103], v[124:127], v[60:63]
    ds_read_b128 v[144:147], v195 offset:16384
    v_mfma_f32_16x16x32_bf16 v[56:59], v[100:103], v[120:123], v[56:59]
    ds_read_b128 v[148:151], v195 offset:18432
    buffer_load_dwordx4 v12, s[24:27], s61 offen offset:2048 lds
    v_mfma_f32_16x16x32_bf16 v[52:55], v[100:103], v[116:119], v[52:55]
    ds_read_b128 v[152:155], v195 offset:20480
    v_mfma_f32_16x16x32_bf16 v[48:51], v[100:103], v[112:115], v[48:51]
    ds_read_b128 v[156:159], v195 offset:22528
    s_waitcnt lgkmcnt(8)
    v_mfma_f32_16x16x32_bf16 v[64:67], v[104:107], v[112:115], v[64:67]
    ds_read_b64_tr_b16 v[132:133], v203 offset:8192
    buffer_load_dwordx4 v13, s[24:27], s61 offen offset:3072 lds
    v_mfma_f32_16x16x32_bf16 v[68:71], v[104:107], v[116:119], v[68:71]
    ds_read_b64_tr_b16 v[134:135], v203 offset:9216
    v_mfma_f32_16x16x32_bf16 v[72:75], v[104:107], v[120:123], v[72:75]
    ds_read_b64_tr_b16 v[136:137], v204 offset:8192
    v_mfma_f32_16x16x32_bf16 v[76:79], v[104:107], v[124:127], v[76:79]
    ds_read_b64_tr_b16 v[138:139], v204 offset:9216
    s_waitcnt lgkmcnt(10)
    v_mfma_f32_16x16x32_bf16 v[92:95], v[108:111], v[124:127], v[92:95]
    ds_read_b64_tr_b16 v[140:141], v205 offset:8192
    v_mfma_f32_16x16x32_bf16 v[88:91], v[108:111], v[120:123], v[88:91]
    ds_read_b64_tr_b16 v[142:143], v205 offset:9216
    s_add_u32 m0, s55, 135168
    s_add_u32 s46, s61, 32768
    v_mfma_f32_16x16x32_bf16 v[84:87], v[108:111], v[116:119], v[84:87]
    buffer_load_dwordx4 v10, s[24:27], s46 offen offset:0 lds
    v_mfma_f32_16x16x32_bf16 v[80:83], v[108:111], v[112:115], v[80:83]
    s_waitcnt lgkmcnt(6)
    v_mfma_f32_16x16x32_bf16 v[32:35], v[128:131], v[144:147], v[32:35]
    buffer_load_dwordx4 v11, s[24:27], s46 offen offset:1024 lds
    v_mfma_f32_16x16x32_bf16 v[36:39], v[128:131], v[148:151], v[36:39]
    v_mfma_f32_16x16x32_bf16 v[40:43], v[128:131], v[152:155], v[40:43]
    buffer_load_dwordx4 v12, s[24:27], s46 offen offset:2048 lds
    v_mfma_f32_16x16x32_bf16 v[44:47], v[128:131], v[156:159], v[44:47]
    s_waitcnt lgkmcnt(4)
    v_mfma_f32_16x16x32_bf16 v[60:63], v[132:135], v[156:159], v[60:63]
    buffer_load_dwordx4 v13, s[24:27], s46 offen offset:3072 lds
    v_mfma_f32_16x16x32_bf16 v[56:59], v[132:135], v[152:155], v[56:59]
    v_mfma_f32_16x16x32_bf16 v[52:55], v[132:135], v[148:151], v[52:55]
    v_mfma_f32_16x16x32_bf16 v[48:51], v[132:135], v[144:147], v[48:51]
    s_waitcnt vmcnt(8) lgkmcnt(0)
    s_barrier
    v_mfma_f32_16x16x32_bf16 v[64:67], v[136:139], v[144:147], v[64:67]
    ds_read_b64_tr_b16 v[96:97], v202 offset:32768
    ds_read_b64_tr_b16 v[98:99], v202 offset:33792
    v_mfma_f32_16x16x32_bf16 v[68:71], v[136:139], v[148:151], v[68:71]
    ds_read_b128 v[112:115], v194 offset:49152
    ds_read_b128 v[116:119], v194 offset:51200
    v_mfma_f32_16x16x32_bf16 v[72:75], v[136:139], v[152:155], v[72:75]
    ds_read_b128 v[120:123], v194 offset:53248
    ds_read_b128 v[124:127], v194 offset:55296
    v_mfma_f32_16x16x32_bf16 v[76:79], v[136:139], v[156:159], v[76:79]
    ds_read_b64_tr_b16 v[100:101], v203 offset:32768
    v_mfma_f32_16x16x32_bf16 v[92:95], v[140:143], v[156:159], v[92:95]
    ds_read_b64_tr_b16 v[102:103], v203 offset:33792
    v_mfma_f32_16x16x32_bf16 v[88:91], v[140:143], v[152:155], v[88:91]
    ds_read_b64_tr_b16 v[104:105], v204 offset:32768
    s_add_u32 m0, s55, 0
    v_mfma_f32_16x16x32_bf16 v[84:87], v[140:143], v[148:151], v[84:87]
    ds_read_b64_tr_b16 v[106:107], v204 offset:33792
    buffer_load_dwordx4 v10, s[24:27], s62 offen offset:0 lds
    v_mfma_f32_16x16x32_bf16 v[80:83], v[140:143], v[144:147], v[80:83]
    s_waitcnt lgkmcnt(4)
    v_mfma_f32_16x16x32_bf16 v[32:35], v[96:99], v[112:115], v[32:35]
    ds_read_b64_tr_b16 v[108:109], v205 offset:32768
    v_mfma_f32_16x16x32_bf16 v[36:39], v[96:99], v[116:119], v[36:39]
    ds_read_b64_tr_b16 v[110:111], v205 offset:33792
    buffer_load_dwordx4 v11, s[24:27], s62 offen offset:1024 lds
    v_mfma_f32_16x16x32_bf16 v[40:43], v[96:99], v[120:123], v[40:43]
    ds_read_b64_tr_b16 v[128:129], v202 offset:40960
    v_mfma_f32_16x16x32_bf16 v[44:47], v[96:99], v[124:127], v[44:47]
    ds_read_b64_tr_b16 v[130:131], v202 offset:41984
    s_waitcnt lgkmcnt(6)
    v_mfma_f32_16x16x32_bf16 v[60:63], v[100:103], v[124:127], v[60:63]
    ds_read_b128 v[144:147], v195 offset:49152
    buffer_load_dwordx4 v12, s[24:27], s62 offen offset:2048 lds
    v_mfma_f32_16x16x32_bf16 v[56:59], v[100:103], v[120:123], v[56:59]
    ds_read_b128 v[148:151], v195 offset:51200
    v_mfma_f32_16x16x32_bf16 v[52:55], v[100:103], v[116:119], v[52:55]
    ds_read_b128 v[152:155], v195 offset:53248
    v_mfma_f32_16x16x32_bf16 v[48:51], v[100:103], v[112:115], v[48:51]
    ds_read_b128 v[156:159], v195 offset:55296
    buffer_load_dwordx4 v13, s[24:27], s62 offen offset:3072 lds
    s_waitcnt lgkmcnt(8)
    v_mfma_f32_16x16x32_bf16 v[64:67], v[104:107], v[112:115], v[64:67]
    ds_read_b64_tr_b16 v[132:133], v203 offset:40960
    s_add_u32 m0, s55, 4096
    s_add_u32 s46, s62, 32768
    v_mfma_f32_16x16x32_bf16 v[68:71], v[104:107], v[116:119], v[68:71]
    ds_read_b64_tr_b16 v[134:135], v203 offset:41984
    buffer_load_dwordx4 v10, s[24:27], s46 offen offset:0 lds
    v_mfma_f32_16x16x32_bf16 v[72:75], v[104:107], v[120:123], v[72:75]
    ds_read_b64_tr_b16 v[136:137], v204 offset:40960
    v_mfma_f32_16x16x32_bf16 v[76:79], v[104:107], v[124:127], v[76:79]
    ds_read_b64_tr_b16 v[138:139], v204 offset:41984
    buffer_load_dwordx4 v11, s[24:27], s46 offen offset:1024 lds
    s_waitcnt lgkmcnt(10)
    v_mfma_f32_16x16x32_bf16 v[92:95], v[108:111], v[124:127], v[92:95]
    ds_read_b64_tr_b16 v[140:141], v205 offset:40960
    v_mfma_f32_16x16x32_bf16 v[88:91], v[108:111], v[120:123], v[88:91]
    ds_read_b64_tr_b16 v[142:143], v205 offset:41984
    buffer_load_dwordx4 v12, s[24:27], s46 offen offset:2048 lds
    v_mfma_f32_16x16x32_bf16 v[84:87], v[108:111], v[116:119], v[84:87]
    v_mfma_f32_16x16x32_bf16 v[80:83], v[108:111], v[112:115], v[80:83]
    buffer_load_dwordx4 v13, s[24:27], s46 offen offset:3072 lds
    s_waitcnt lgkmcnt(4)
    v_mfma_f32_16x16x32_bf16 v[32:35], v[128:131], v[144:147], v[32:35]
    v_mfma_f32_16x16x32_bf16 v[36:39], v[128:131], v[148:151], v[36:39]
    v_mfma_f32_16x16x32_bf16 v[40:43], v[128:131], v[152:155], v[40:43]
    v_mfma_f32_16x16x32_bf16 v[44:47], v[128:131], v[156:159], v[44:47]
    v_readfirstlane_b32 s81, v21
    s_mov_b32 s63, 0x40000
L_non_U:
    s_cmp_lg_u32 s81, 0
    s_cbranch_scc1 L_nonok_U
    buffer_load_dwordx2 v[20:21], v18, s[32:35], 0 offen sc1
    s_waitcnt vmcnt(0)
    v_readfirstlane_b32 s81, v21
    s_sub_u32 s63, s63, 1
    s_cbranch_scc0 L_non_U
L_nonok_U:
    v_readfirstlane_b32 s80, v20
    s_mov_b32 s43, 57344
    s_mov_b32 s44, 114688
    s_mov_b32 s45, 172032
    v_mfma_f32_16x16x32_bf16 v[60:63], v[132:135], v[156:159], v[60:63]
    v_mfma_f32_16x16x32_bf16 v[56:59], v[132:135], v[152:155], v[56:59]
    v_mfma_f32_16x16x32_bf16 v[52:55], v[132:135], v[148:151], v[52:55]
    v_mfma_f32_16x16x32_bf16 v[48:51], v[132:135], v[144:147], v[48:51]
    s_waitcnt lgkmcnt(0)
    v_mfma_f32_16x16x32_bf16 v[64:67], v[136:139], v[144:147], v[64:67]
    v_mfma_f32_16x16x32_bf16 v[68:71], v[136:139], v[148:151], v[68:71]
    s_nop 2
    v_mfma_f32_16x16x32_bf16 v[72:75], v[136:139], v[152:155], v[72:75]
    v_cvt_pk_bf16_f32 v172, v44, v45
    v_cvt_pk_bf16_f32 v173, v46, v47
    v_cvt_pk_bf16_f32 v174, v60, v61
    v_mfma_f32_16x16x32_bf16 v[76:79], v[136:139], v[156:159], v[76:79]
    v_cvt_pk_bf16_f32 v175, v62, v63
    v_pk_max_i16 v172, v172, 0
    v_pk_max_i16 v173, v173, 0
    v_mfma_f32_16x16x32_bf16 v[92:95], v[140:143], v[156:159], v[92:95]
    v_pk_max_i16 v174, v174, 0
    v_pk_max_i16 v175, v175, 0
    buffer_store_dwordx4 v[172:175], v22, s[36:39], s45 offen offset:0 sc1
    v_mfma_f32_16x16x32_bf16 v[88:91], v[140:143], v[152:155], v[88:91]
    v_cvt_pk_bf16_f32 v168, v40, v41
    v_cvt_pk_bf16_f32 v169, v42, v43
    v_cvt_pk_bf16_f32 v170, v56, v57
    v_mfma_f32_16x16x32_bf16 v[84:87], v[140:143], v[148:151], v[84:87]
    v_cvt_pk_bf16_f32 v171, v58, v59
    v_pk_max_i16 v168, v168, 0
    v_pk_max_i16 v169, v169, 0
    v_mfma_f32_16x16x32_bf16 v[80:83], v[140:143], v[144:147], v[80:83]
    v_pk_max_i16 v170, v170, 0
    v_pk_max_i16 v171, v171, 0
    buffer_store_dwordx4 v[168:171], v22, s[36:39], s44 offen offset:0 sc1
    v_cvt_pk_bf16_f32 v164, v36, v37
    v_cvt_pk_bf16_f32 v165, v38, v39
    v_cvt_pk_bf16_f32 v166, v52, v53
    v_cvt_pk_bf16_f32 v167, v54, v55
    v_pk_max_i16 v164, v164, 0
    v_pk_max_i16 v165, v165, 0
    v_pk_max_i16 v166, v166, 0
    v_pk_max_i16 v167, v167, 0
    buffer_store_dwordx4 v[164:167], v22, s[36:39], s43 offen offset:0 sc1
    v_cvt_pk_bf16_f32 v160, v32, v33
    v_cvt_pk_bf16_f32 v161, v34, v35
    v_cvt_pk_bf16_f32 v162, v48, v49
    v_cvt_pk_bf16_f32 v163, v50, v51
    v_pk_max_i16 v160, v160, 0
    v_pk_max_i16 v161, v161, 0
    v_pk_max_i16 v162, v162, 0
    v_pk_max_i16 v163, v163, 0
    buffer_store_dwordx4 v[160:163], v22, s[36:39], 0 offen offset:0 sc1
    v_cvt_pk_bf16_f32 v188, v76, v77
    v_cvt_pk_bf16_f32 v189, v78, v79
    v_cvt_pk_bf16_f32 v190, v92, v93
    v_cvt_pk_bf16_f32 v191, v94, v95
    v_pk_max_i16 v188, v188, 0
    v_pk_max_i16 v189, v189, 0
    v_pk_max_i16 v190, v190, 0
    v_pk_max_i16 v191, v191, 0
    buffer_store_dwordx4 v[188:191], v22, s[36:39], s45 offen offset:1024 sc1
    v_cvt_pk_bf16_f32 v184, v72, v73
    v_cvt_pk_bf16_f32 v185, v74, v75
    v_cvt_pk_bf16_f32 v186, v88, v89
    v_cvt_pk_bf16_f32 v187, v90, v91
    v_pk_max_i16 v184, v184, 0
    v_pk_max_i16 v185, v185, 0
    v_pk_max_i16 v186, v186, 0
    v_pk_max_i16 v187, v187, 0
    buffer_store_dwordx4 v[184:187], v22, s[36:39], s44 offen offset:1024 sc1
    v_cvt_pk_bf16_f32 v180, v68, v69
    v_cvt_pk_bf16_f32 v181, v70, v71
    v_cvt_pk_bf16_f32 v182, v84, v85
    v_cvt_pk_bf16_f32 v183, v86, v87
    v_pk_max_i16 v180, v180, 0
    v_pk_max_i16 v181, v181, 0
    v_pk_max_i16 v182, v182, 0
    v_pk_max_i16 v183, v183, 0
    buffer_store_dwordx4 v[180:183], v22, s[36:39], s43 offen offset:1024 sc1
    v_cvt_pk_bf16_f32 v176, v64, v65
    v_cvt_pk_bf16_f32 v177, v66, v67
    v_cvt_pk_bf16_f32 v178, v80, v81
    v_cvt_pk_bf16_f32 v179, v82, v83
    v_pk_max_i16 v176, v176, 0
    v_pk_max_i16 v177, v177, 0
    v_pk_max_i16 v178, v178, 0
    v_pk_max_i16 v179, v179, 0
    buffer_store_dwordx4 v[176:179], v22, s[36:39], 0 offen offset:1024 sc1
    s_barrier
    s_add_u32 m0, s55, 32768
    s_nop 0
    buffer_load_dwordx4 v10, s[24:27], s57 offen offset:0 lds
    buffer_load_dwordx4 v11, s[24:27], s57 offen offset:1024 lds
    buffer_load_dwordx4 v12, s[24:27], s57 offen offset:2048 lds
    buffer_load_dwordx4 v13, s[24:27], s57 offen offset:3072 lds
    s_add_u32 m0, s55, 36864
    s_add_u32 s46, s57, 32768
    buffer_load_dwordx4 v10, s[24:27], s46 offen offset:0 lds
    buffer_load_dwordx4 v11, s[24:27], s46 offen offset:1024 lds
    buffer_load_dwordx4 v12, s[24:27], s46 offen offset:2048 lds
    buffer_load_dwordx4 v13, s[24:27], s46 offen offset:3072 lds
    s_waitcnt vmcnt(24) lgkmcnt(4)
    ds_read_b64_tr_b16 a[160:161], v218 offset:0
    ds_read_b64_tr_b16 a[162:163], v218 offset:2048
    ds_read_b64_tr_b16 a[164:165], v219 offset:0
    ds_read_b64_tr_b16 a[166:167], v219 offset:2048
    ds_read_b64_tr_b16 a[168:169], v220 offset:0
    ds_read_b64_tr_b16 a[170:171], v220 offset:2048
    ds_read_b64_tr_b16 a[172:173], v221 offset:0
    ds_read_b64_tr_b16 a[174:175], v221 offset:2048
    s_waitcnt lgkmcnt(4)
    ds_read_b64_tr_b16 a[176:177], v218 offset:4096
    ds_read_b64_tr_b16 a[178:179], v218 offset:6144
    ds_read_b64_tr_b16 a[180:181], v219 offset:4096
    ds_read_b64_tr_b16 a[182:183], v219 offset:6144
    ds_read_b64_tr_b16 a[184:185], v220 offset:4096
    ds_read_b64_tr_b16 a[186:187], v220 offset:6144
    ds_read_b64_tr_b16 a[188:189], v221 offset:4096
    ds_read_b64_tr_b16 a[190:191], v221 offset:6144
    s_waitcnt vmcnt(16) lgkmcnt(4)
    ds_read_b64_tr_b16 a[192:193], v210 offset:0
    ds_read_b64_tr_b16 a[194:195], v210 offset:2048
    ds_read_b64_tr_b16 a[196:197], v211 offset:0
    ds_read_b64_tr_b16 a[198:199], v211 offset:2048
    ds_read_b64_tr_b16 a[200:201], v212 offset:0
    ds_read_b64_tr_b16 a[202:203], v212 offset:2048
    ds_read_b64_tr_b16 a[204:205], v213 offset:0
    ds_read_b64_tr_b16 a[206:207], v213 offset:2048
    s_waitcnt lgkmcnt(4)
    ds_read_b64_tr_b16 a[208:209], v210 offset:4096
    ds_read_b64_tr_b16 a[210:211], v210 offset:6144
    ds_read_b64_tr_b16 a[212:213], v211 offset:4096
    ds_read_b64_tr_b16 a[214:215], v211 offset:6144
    ds_read_b64_tr_b16 a[216:217], v212 offset:4096
    ds_read_b64_tr_b16 a[218:219], v212 offset:6144
    ds_read_b64_tr_b16 a[220:221], v213 offset:4096
    ds_read_b64_tr_b16 a[222:223], v213 offset:6144
    s_waitcnt vmcnt(8) lgkmcnt(0)
    s_atomic_swap_x2 s[80:81], s[8:9], 0
    s_add_u32 m0, s55, 65536
    s_nop 0
    buffer_load_dwordx4 v10, s[24:27], s58 offen offset:0 lds
    buffer_load_dwordx4 v11, s[24:27], s58 offen offset:1024 lds
    buffer_load_dwordx4 v12, s[24:27], s58 offen offset:2048 lds
    buffer_load_dwordx4 v13, s[24:27], s58 offen offset:3072 lds
    s_add_u32 m0, s55, 69632
    s_add_u32 s46, s58, 32768
    buffer_load_dwordx4 v10, s[24:27], s46 offen offset:0 lds
    buffer_load_dwordx4 v11, s[24:27], s46 offen offset:1024 lds
    buffer_load_dwordx4 v12, s[24:27], s46 offen offset:2048 lds
    buffer_load_dwordx4 v13, s[24:27], s46 offen offset:3072 lds
    s_add_u32 m0, s55, 98304
    s_nop 0
    buffer_load_dwordx4 v10, s[24:27], s59 offen offset:0 lds
    buffer_load_dwordx4 v11, s[24:27], s59 offen offset:1024 lds
    buffer_load_dwordx4 v12, s[24:27], s59 offen offset:2048 lds
    buffer_load_dwordx4 v13, s[24:27], s59 offen offset:3072 lds
    s_add_u32 m0, s55, 102400
    s_add_u32 s46, s59, 32768
    buffer_load_dwordx4 v10, s[24:27], s46 offen offset:0 lds
    buffer_load_dwordx4 v11, s[24:27], s46 offen offset:1024 lds
    buffer_load_dwordx4 v12, s[24:27], s46 offen offset:2048 lds
    buffer_load_dwordx4 v13, s[24:27], s46 offen offset:3072 lds
    s_waitcnt vmcnt(16) lgkmcnt(4)
    ds_read_b64_tr_b16 a[32:33], v210 offset:32768
    ds_read_b64_tr_b16 a[34:35], v210 offset:34816
    ds_read_b64_tr_b16 a[36:37], v211 offset:32768
    ds_read_b64_tr_b16 a[38:39], v211 offset:34816
    ds_read_b64_tr_b16 a[40:41], v212 offset:32768
    ds_read_b64_tr_b16 a[42:43], v212 offset:34816
    ds_read_b64_tr_b16 a[44:45], v213 offset:32768
    ds_read_b64_tr_b16 a[46:47], v213 offset:34816
    s_waitcnt lgkmcnt(4)
    ds_read_b64_tr_b16 a[48:49], v210 offset:36864
    ds_read_b64_tr_b16 a[50:51], v210 offset:38912
    ds_read_b64_tr_b16 a[52:53], v211 offset:36864
    ds_read_b64_tr_b16 a[54:55], v211 offset:38912
    ds_read_b64_tr_b16 a[56:57], v212 offset:36864
    ds_read_b64_tr_b16 a[58:59], v212 offset:38912
    ds_read_b64_tr_b16 a[60:61], v213 offset:36864
    ds_read_b64_tr_b16 a[62:63], v213 offset:38912
    s_add_u32 m0, s55, 131072
    s_nop 0
    buffer_load_dwordx4 v10, s[24:27], s60 offen offset:0 lds
    buffer_load_dwordx4 v11, s[24:27], s60 offen offset:1024 lds
    buffer_load_dwordx4 v12, s[24:27], s60 offen offset:2048 lds
    buffer_load_dwordx4 v13, s[24:27], s60 offen offset:3072 lds
    s_load_dwordx16 s[64:79], s[82:83], 0 glc
    s_add_u32 m0, s55, 135168
    s_add_u32 s46, s60, 32768
    buffer_load_dwordx4 v10, s[24:27], s46 offen offset:0 lds
    buffer_load_dwordx4 v11, s[24:27], s46 offen offset:1024 lds
    buffer_load_dwordx4 v12, s[24:27], s46 offen offset:2048 lds
    buffer_load_dwordx4 v13, s[24:27], s46 offen offset:3072 lds
    s_mov_b32 s63, 0x40000
    s_branch L_check_U
L_poll_U:
    s_load_dwordx16 s[64:79], s[82:83], 0 glc
    s_sub_u32 s63, s63, 1
    s_cbranch_scc1 L_ready_U
L_check_U:
    s_waitcnt lgkmcnt(0)
    s_cmp_lg_u64 s[64:65], s[80:81]
    s_cbranch_scc1 L_poll_U
    s_cmp_lg_u64 s[66:67], s[80:81]
    s_cbranch_scc1 L_poll_U
    s_cmp_lg_u64 s[68:69], s[80:81]
    s_cbranch_scc1 L_poll_U
    s_cmp_lg_u64 s[70:71], s[80:81]
    s_cbranch_scc1 L_poll_U
    s_cmp_lg_u64 s[72:73], s[80:81]
    s_cbranch_scc1 L_poll_U
    s_cmp_lg_u64 s[74:75], s[80:81]
    s_cbranch_scc1 L_poll_U
    s_cmp_lg_u64 s[76:77], s[80:81]
    s_cbranch_scc1 L_poll_U
L_ready_U:
    buffer_load_dwordx4 v[96:99], v14, s[36:39], s48 offen offset:0 sc1
    buffer_load_dwordx4 v[100:103], v14, s[36:39], s48 offen offset:1024 sc1
    buffer_load_dwordx4 v[104:107], v14, s[36:39], s49 offen offset:0 sc1
    buffer_load_dwordx4 v[108:111], v14, s[36:39], s49 offen offset:1024 sc1
    buffer_load_dwordx4 v[112:115], v14, s[36:39], s50 offen offset:0 sc1
    s_barrier
    buffer_load_dwordx4 v[116:119], v14, s[36:39], s50 offen offset:1024 sc1
    buffer_load_dwordx4 v[120:123], v14, s[36:39], s51 offen offset:0 sc1
    buffer_load_dwordx4 v[124:127], v14, s[36:39], s51 offen offset:1024 sc1
    buffer_load_dwordx4 v[128:131], v14, s[36:39], s52 offen offset:0 sc1
    buffer_load_dwordx4 v[132:135], v14, s[36:39], s52 offen offset:1024 sc1
    s_waitcnt vmcnt(26) lgkmcnt(4)
    ds_read_b64_tr_b16 a[64:65], v214 offset:0
    ds_read_b64_tr_b16 a[66:67], v214 offset:2048
    ds_read_b64_tr_b16 a[68:69], v215 offset:0
    ds_read_b64_tr_b16 a[70:71], v215 offset:2048
    ds_read_b64_tr_b16 a[72:73], v216 offset:0
    ds_read_b64_tr_b16 a[74:75], v216 offset:2048
    ds_read_b64_tr_b16 a[76:77], v217 offset:0
    ds_read_b64_tr_b16 a[78:79], v217 offset:2048
    s_waitcnt lgkmcnt(4)
    ds_read_b64_tr_b16 a[80:81], v214 offset:4096
    ds_read_b64_tr_b16 a[82:83], v214 offset:6144
    ds_read_b64_tr_b16 a[84:85], v215 offset:4096
    ds_read_b64_tr_b16 a[86:87], v215 offset:6144
    ds_read_b64_tr_b16 a[88:89], v216 offset:4096
    ds_read_b64_tr_b16 a[90:91], v216 offset:6144
    ds_read_b64_tr_b16 a[92:93], v217 offset:4096
    ds_read_b64_tr_b16 a[94:95], v217 offset:6144
    s_waitcnt vmcnt(18) lgkmcnt(4)
    ds_read_b64_tr_b16 a[96:97], v214 offset:32768
    ds_read_b64_tr_b16 a[98:99], v214 offset:34816
    ds_read_b64_tr_b16 a[100:101], v215 offset:32768
    ds_read_b64_tr_b16 a[102:103], v215 offset:34816
    ds_read_b64_tr_b16 a[104:105], v216 offset:32768
    ds_read_b64_tr_b16 a[106:107], v216 offset:34816
    ds_read_b64_tr_b16 a[108:109], v217 offset:32768
    ds_read_b64_tr_b16 a[110:111], v217 offset:34816
    s_waitcnt lgkmcnt(4)
    ds_read_b64_tr_b16 a[112:113], v214 offset:36864
    ds_read_b64_tr_b16 a[114:115], v214 offset:38912
    ds_read_b64_tr_b16 a[116:117], v215 offset:36864
    ds_read_b64_tr_b16 a[118:119], v215 offset:38912
    ds_read_b64_tr_b16 a[120:121], v216 offset:36864
    ds_read_b64_tr_b16 a[122:123], v216 offset:38912
    ds_read_b64_tr_b16 a[124:125], v217 offset:36864
    ds_read_b64_tr_b16 a[126:127], v217 offset:38912
    s_waitcnt vmcnt(10) lgkmcnt(4)
    ds_read_b64_tr_b16 a[128:129], v218 offset:0
    ds_read_b64_tr_b16 a[130:131], v218 offset:2048
    ds_read_b64_tr_b16 a[132:133], v219 offset:0
    ds_read_b64_tr_b16 a[134:135], v219 offset:2048
    ds_read_b64_tr_b16 a[136:137], v220 offset:0
    ds_read_b64_tr_b16 a[138:139], v220 offset:2048
    ds_read_b64_tr_b16 a[140:141], v221 offset:0
    ds_read_b64_tr_b16 a[142:143], v221 offset:2048
    s_waitcnt lgkmcnt(4)
    ds_read_b64_tr_b16 a[144:145], v218 offset:4096
    ds_read_b64_tr_b16 a[146:147], v218 offset:6144
    ds_read_b64_tr_b16 a[148:149], v219 offset:4096
    ds_read_b64_tr_b16 a[150:151], v219 offset:6144
    ds_read_b64_tr_b16 a[152:153], v220 offset:4096
    ds_read_b64_tr_b16 a[154:155], v220 offset:6144
    ds_read_b64_tr_b16 a[156:157], v221 offset:4096
    ds_read_b64_tr_b16 a[158:159], v221 offset:6144
L_p2:
    s_waitcnt vmcnt(9)
    v_mfma_f32_16x16x32_bf16 v[32:35], a[0:3], v[96:99], 0
    buffer_load_dwordx4 v[136:139], v14, s[36:39], s53 offen offset:0 sc1
    v_mfma_f32_16x16x32_bf16 v[36:39], a[4:7], v[96:99], 0
    v_mfma_f32_16x16x32_bf16 v[40:43], a[8:11], v[96:99], 0
    v_mfma_f32_16x16x32_bf16 v[44:47], a[12:15], v[96:99], 0
    s_waitcnt vmcnt(9) lgkmcnt(0)
    v_mfma_f32_16x16x32_bf16 v[44:47], a[28:31], v[100:103], v[44:47]
    buffer_load_dwordx4 v[140:143], v14, s[36:39], s53 offen offset:1024 sc1
    v_mfma_f32_16x16x32_bf16 v[40:43], a[24:27], v[100:103], v[40:43]
    v_mfma_f32_16x16x32_bf16 v[36:39], a[20:23], v[100:103], v[36:39]
    v_mfma_f32_16x16x32_bf16 v[32:35], a[16:19], v[100:103], v[32:35]
    s_waitcnt vmcnt(9)
    v_mfma_f32_16x16x32_bf16 v[32:35], a[32:35], v[104:107], v[32:35]
    buffer_load_dwordx4 v[144:147], v14, s[36:39], s54 offen offset:0 sc1
    v_mfma_f32_16x16x32_bf16 v[36:39], a[36:39], v[104:107], v[36:39]
    v_mfma_f32_16x16x32_bf16 v[40:43], a[40:43], v[104:107], v[40:43]
    v_mfma_f32_16x16x32_bf16 v[44:47], a[44:47], v[104:107], v[44:47]
    s_waitcnt vmcnt(9)
    v_mfma_f32_16x16x32_bf16 v[44:47], a[60:63], v[108:111], v[44:47]
    buffer_load_dwordx4 v[148:151], v14, s[36:39], s54 offen offset:1024 sc1
    v_mfma_f32_16x16x32_bf16 v[40:43], a[56:59], v[108:111], v[40:43]
    v_mfma_f32_16x16x32_bf16 v[36:39], a[52:55], v[108:111], v[36:39]
    v_mfma_f32_16x16x32_bf16 v[32:35], a[48:51], v[108:111], v[32:35]
    s_waitcnt vmcnt(9)
    v_mfma_f32_16x16x32_bf16 v[32:35], a[64:67], v[112:115], v[32:35]
    buffer_load_dwordx4 v[152:155], v15, s[36:39], s48 offen offset:0 sc1
    v_mfma_f32_16x16x32_bf16 v[36:39], a[68:71], v[112:115], v[36:39]
    s_add_u32 s43, s11, 0
    v_mfma_f32_16x16x32_bf16 v[40:43], a[72:75], v[112:115], v[40:43]
    s_and_b32 s43, s43, 3
    v_mfma_f32_16x16x32_bf16 v[44:47], a[76:79], v[112:115], v[44:47]
    s_lshl_b32 s43, s43, 14
    s_waitcnt vmcnt(9)
    v_mfma_f32_16x16x32_bf16 v[44:47], a[92:95], v[116:119], v[44:47]
    buffer_load_dwordx4 v[156:159], v15, s[36:39], s48 offen offset:1024 sc1
    v_mfma_f32_16x16x32_bf16 v[40:43], a[88:91], v[116:119], v[40:43]
    s_add_u32 s44, s11, 1
    v_mfma_f32_16x16x32_bf16 v[36:39], a[84:87], v[116:119], v[36:39]
    s_and_b32 s44, s44, 3
    v_mfma_f32_16x16x32_bf16 v[32:35], a[80:83], v[116:119], v[32:35]
    s_lshl_b32 s44, s44, 14
    s_waitcnt vmcnt(9)
    v_mfma_f32_16x16x32_bf16 v[32:35], a[96:99], v[120:123], v[32:35]
    buffer_load_dwordx4 v[96:99], v15, s[36:39], s49 offen offset:0 sc1
    v_mfma_f32_16x16x32_bf16 v[36:39], a[100:103], v[120:123], v[36:39]
    s_add_u32 s45, s11, 2
    v_mfma_f32_16x16x32_bf16 v[40:43], a[104:107], v[120:123], v[40:43]
    s_and_b32 s45, s45, 3
    v_mfma_f32_16x16x32_bf16 v[44:47], a[108:111], v[120:123], v[44:47]
    s_lshl_b32 s45, s45, 14
    s_waitcnt vmcnt(9)
    v_mfma_f32_16x16x32_bf16 v[44:47], a[124:127], v[124:127], v[44:47]
    buffer_load_dwordx4 v[100:103], v15, s[36:39], s49 offen offset:1024 sc1
    v_mfma_f32_16x16x32_bf16 v[40:43], a[120:123], v[124:127], v[40:43]
    s_add_u32 s46, s11, 3
    v_mfma_f32_16x16x32_bf16 v[36:39], a[116:119], v[124:127], v[36:39]
    s_and_b32 s46, s46, 3
    v_mfma_f32_16x16x32_bf16 v[32:35], a[112:115], v[124:127], v[32:35]
    s_lshl_b32 s46, s46, 14
    s_waitcnt vmcnt(9)
    v_mfma_f32_16x16x32_bf16 v[32:35], a[128:131], v[128:131], v[32:35]
    buffer_load_dwordx4 v[104:107], v15, s[36:39], s50 offen offset:0 sc1
    v_mfma_f32_16x16x32_bf16 v[36:39], a[132:135], v[128:131], v[36:39]
    v_mfma_f32_16x16x32_bf16 v[40:43], a[136:139], v[128:131], v[40:43]
    v_mfma_f32_16x16x32_bf16 v[44:47], a[140:143], v[128:131], v[44:47]
    s_waitcnt vmcnt(9)
    v_mfma_f32_16x16x32_bf16 v[44:47], a[156:159], v[132:135], v[44:47]
    buffer_load_dwordx4 v[108:111], v15, s[36:39], s50 offen offset:1024 sc1
    v_mfma_f32_16x16x32_bf16 v[40:43], a[152:155], v[132:135], v[40:43]
    v_mfma_f32_16x16x32_bf16 v[36:39], a[148:151], v[132:135], v[36:39]
    v_mfma_f32_16x16x32_bf16 v[32:35], a[144:147], v[132:135], v[32:35]
    s_waitcnt vmcnt(9)
    v_mfma_f32_16x16x32_bf16 v[32:35], a[160:163], v[136:139], v[32:35]
    buffer_load_dwordx4 v[112:115], v15, s[36:39], s51 offen offset:0 sc1
    v_mfma_f32_16x16x32_bf16 v[36:39], a[164:167], v[136:139], v[36:39]
    v_mfma_f32_16x16x32_bf16 v[40:43], a[168:171], v[136:139], v[40:43]
    v_mfma_f32_16x16x32_bf16 v[44:47], a[172:175], v[136:139], v[44:47]
    s_waitcnt vmcnt(9)
    v_mfma_f32_16x16x32_bf16 v[44:47], a[188:191], v[140:143], v[44:47]
    buffer_load_dwordx4 v[116:119], v15, s[36:39], s51 offen offset:1024 sc1
    v_mfma_f32_16x16x32_bf16 v[40:43], a[184:187], v[140:143], v[40:43]
    v_mfma_f32_16x16x32_bf16 v[36:39], a[180:183], v[140:143], v[36:39]
    v_mfma_f32_16x16x32_bf16 v[32:35], a[176:179], v[140:143], v[32:35]
    s_waitcnt vmcnt(9)
    v_mfma_f32_16x16x32_bf16 v[32:35], a[192:195], v[144:147], v[32:35]
    buffer_load_dwordx4 v[120:123], v15, s[36:39], s52 offen offset:0 sc1
    v_mfma_f32_16x16x32_bf16 v[36:39], a[196:199], v[144:147], v[36:39]
    v_mfma_f32_16x16x32_bf16 v[40:43], a[200:203], v[144:147], v[40:43]
    v_mfma_f32_16x16x32_bf16 v[44:47], a[204:207], v[144:147], v[44:47]
    s_waitcnt vmcnt(9)
    v_mfma_f32_16x16x32_bf16 v[44:47], a[220:223], v[148:151], v[44:47]
    buffer_load_dwordx4 v[124:127], v15, s[36:39], s52 offen offset:1024 sc1
    v_mfma_f32_16x16x32_bf16 v[40:43], a[216:219], v[148:151], v[40:43]
    v_mfma_f32_16x16x32_bf16 v[36:39], a[212:215], v[148:151], v[36:39]
    v_mfma_f32_16x16x32_bf16 v[32:35], a[208:211], v[148:151], v[32:35]
    s_waitcnt vmcnt(9)
    v_mfma_f32_16x16x32_bf16 v[48:51], a[0:3], v[152:155], 0
    buffer_load_dwordx4 v[128:131], v15, s[36:39], s53 offen offset:0 sc1
    v_mfma_f32_16x16x32_bf16 v[52:55], a[4:7], v[152:155], 0
    v_mfma_f32_16x16x32_bf16 v[56:59], a[8:11], v[152:155], 0
    v_mfma_f32_16x16x32_bf16 v[60:63], a[12:15], v[152:155], 0
    s_waitcnt vmcnt(9)
    v_mfma_f32_16x16x32_bf16 v[60:63], a[28:31], v[156:159], v[60:63]
    buffer_load_dwordx4 v[132:135], v15, s[36:39], s53 offen offset:1024 sc1
    v_mfma_f32_16x16x32_bf16 v[56:59], a[24:27], v[156:159], v[56:59]
    ds_write_b128 v24, v[32:35] offset:0
    v_mfma_f32_16x16x32_bf16 v[52:55], a[20:23], v[156:159], v[52:55]
    ds_write_b128 v25, v[36:39] offset:0
    v_mfma_f32_16x16x32_bf16 v[48:51], a[16:19], v[156:159], v[48:51]
    s_waitcnt vmcnt(9)
    v_mfma_f32_16x16x32_bf16 v[48:51], a[32:35], v[96:99], v[48:51]
    buffer_load_dwordx4 v[136:139], v15, s[36:39], s54 offen offset:0 sc1
    v_mfma_f32_16x16x32_bf16 v[52:55], a[36:39], v[96:99], v[52:55]
    ds_write_b128 v24, v[40:43] offset:128
    v_mfma_f32_16x16x32_bf16 v[56:59], a[40:43], v[96:99], v[56:59]
    ds_write_b128 v25, v[44:47] offset:128
    v_mfma_f32_16x16x32_bf16 v[60:63], a[44:47], v[96:99], v[60:63]
    s_waitcnt vmcnt(9)
    v_mfma_f32_16x16x32_bf16 v[60:63], a[60:63], v[100:103], v[60:63]
    buffer_load_dwordx4 v[140:143], v15, s[36:39], s54 offen offset:1024 sc1
    v_mfma_f32_16x16x32_bf16 v[56:59], a[56:59], v[100:103], v[56:59]
    v_mfma_f32_16x16x32_bf16 v[52:55], a[52:55], v[100:103], v[52:55]
    v_mfma_f32_16x16x32_bf16 v[48:51], a[48:51], v[100:103], v[48:51]
    s_waitcnt vmcnt(9)
    v_mfma_f32_16x16x32_bf16 v[48:51], a[64:67], v[104:107], v[48:51]
    buffer_load_dwordx4 v[144:147], v16, s[36:39], s48 offen offset:0 sc1
    v_mfma_f32_16x16x32_bf16 v[52:55], a[68:71], v[104:107], v[52:55]
    s_waitcnt lgkmcnt(0)
    v_mfma_f32_16x16x32_bf16 v[56:59], a[72:75], v[104:107], v[56:59]
    s_barrier
    v_mfma_f32_16x16x32_bf16 v[60:63], a[76:79], v[104:107], v[60:63]
    s_waitcnt vmcnt(9)
    v_mfma_f32_16x16x32_bf16 v[60:63], a[92:95], v[108:111], v[60:63]
    buffer_load_dwordx4 v[148:151], v16, s[36:39], s48 offen offset:1024 sc1
    v_mfma_f32_16x16x32_bf16 v[56:59], a[88:91], v[108:111], v[56:59]
    ds_read_b128 v[232:235], v26 offset:0
    ds_read_b128 v[236:239], v26 offset:8192
    v_mfma_f32_16x16x32_bf16 v[52:55], a[84:87], v[108:111], v[52:55]
    ds_read_b128 v[240:243], v26 offset:16384
    ds_read_b128 v[244:247], v26 offset:24576
    v_mfma_f32_16x16x32_bf16 v[48:51], a[80:83], v[108:111], v[48:51]
    s_waitcnt vmcnt(9)
    v_mfma_f32_16x16x32_bf16 v[48:51], a[96:99], v[112:115], v[48:51]
    buffer_load_dwordx4 v[152:155], v16, s[36:39], s49 offen offset:0 sc1
    v_mfma_f32_16x16x32_bf16 v[52:55], a[100:103], v[112:115], v[52:55]
    v_mfma_f32_16x16x32_bf16 v[56:59], a[104:107], v[112:115], v[56:59]
    v_mfma_f32_16x16x32_bf16 v[60:63], a[108:111], v[112:115], v[60:63]
    s_waitcnt vmcnt(9)
    v_mfma_f32_16x16x32_bf16 v[60:63], a[124:127], v[116:119], v[60:63]
    buffer_load_dwordx4 v[156:159], v16, s[36:39], s49 offen offset:1024 sc1
    v_mfma_f32_16x16x32_bf16 v[56:59], a[120:123], v[116:119], v[56:59]
    s_waitcnt lgkmcnt(0)
    v_add_f32 v232, v232, v236
    v_mfma_f32_16x16x32_bf16 v[52:55], a[116:119], v[116:119], v[52:55]
    v_add_f32 v233, v233, v237
    v_add_f32 v234, v234, v238
    v_mfma_f32_16x16x32_bf16 v[48:51], a[112:115], v[116:119], v[48:51]
    s_waitcnt vmcnt(9)
    v_mfma_f32_16x16x32_bf16 v[48:51], a[128:131], v[120:123], v[48:51]
    buffer_load_dwordx4 v[96:99], v16, s[36:39], s50 offen offset:0 sc1
    v_mfma_f32_16x16x32_bf16 v[52:55], a[132:135], v[120:123], v[52:55]
    v_add_f32 v235, v235, v239
    v_add_f32 v240, v240, v244
    v_mfma_f32_16x16x32_bf16 v[56:59], a[136:139], v[120:123], v[56:59]
    v_add_f32 v241, v241, v245
    v_add_f32 v242, v242, v246
    v_mfma_f32_16x16x32_bf16 v[60:63], a[140:143], v[120:123], v[60:63]
    s_waitcnt vmcnt(9)
    v_mfma_f32_16x16x32_bf16 v[60:63], a[156:159], v[124:127], v[60:63]
    buffer_load_dwordx4 v[100:103], v16, s[36:39], s50 offen offset:1024 sc1
    v_mfma_f32_16x16x32_bf16 v[56:59], a[152:155], v[124:127], v[56:59]
    v_add_f32 v243, v243, v247
    v_add_f32 v232, v232, v240
    v_mfma_f32_16x16x32_bf16 v[52:55], a[148:151], v[124:127], v[52:55]
    v_add_f32 v233, v233, v241
    v_add_f32 v234, v234, v242
    v_mfma_f32_16x16x32_bf16 v[48:51], a[144:147], v[124:127], v[48:51]
    s_waitcnt vmcnt(9)
    v_mfma_f32_16x16x32_bf16 v[48:51], a[160:163], v[128:131], v[48:51]
    buffer_load_dwordx4 v[104:107], v16, s[36:39], s51 offen offset:0 sc1
    v_mfma_f32_16x16x32_bf16 v[52:55], a[164:167], v[128:131], v[52:55]
    v_add_f32 v235, v235, v243
    v_mfma_f32_16x16x32_bf16 v[56:59], a[168:171], v[128:131], v[56:59]
    v_cvt_pk_bf16_f32 v222, v232, v233
    v_mfma_f32_16x16x32_bf16 v[60:63], a[172:175], v[128:131], v[60:63]
    v_cvt_pk_bf16_f32 v223, v234, v235
    s_waitcnt vmcnt(9)
    v_mfma_f32_16x16x32_bf16 v[60:63], a[188:191], v[132:135], v[60:63]
    buffer_load_dwordx4 v[108:111], v16, s[36:39], s51 offen offset:1024 sc1
    v_mfma_f32_16x16x32_bf16 v[56:59], a[184:187], v[132:135], v[56:59]
    v_mfma_f32_16x16x32_bf16 v[52:55], a[180:183], v[132:135], v[52:55]
    v_mfma_f32_16x16x32_bf16 v[48:51], a[176:179], v[132:135], v[48:51]
    s_waitcnt vmcnt(9)
    v_mfma_f32_16x16x32_bf16 v[48:51], a[192:195], v[136:139], v[48:51]
    buffer_load_dwordx4 v[112:115], v16, s[36:39], s52 offen offset:0 sc1
    v_mfma_f32_16x16x32_bf16 v[52:55], a[196:199], v[136:139], v[52:55]
    v_mfma_f32_16x16x32_bf16 v[56:59], a[200:203], v[136:139], v[56:59]
    v_mfma_f32_16x16x32_bf16 v[60:63], a[204:207], v[136:139], v[60:63]
    s_waitcnt vmcnt(9)
    v_mfma_f32_16x16x32_bf16 v[60:63], a[220:223], v[140:143], v[60:63]
    buffer_load_dwordx4 v[116:119], v16, s[36:39], s52 offen offset:1024 sc1
    v_mfma_f32_16x16x32_bf16 v[56:59], a[216:219], v[140:143], v[56:59]
    v_mfma_f32_16x16x32_bf16 v[52:55], a[212:215], v[140:143], v[52:55]
    v_mfma_f32_16x16x32_bf16 v[48:51], a[208:211], v[140:143], v[48:51]
    s_waitcnt vmcnt(9)
    v_mfma_f32_16x16x32_bf16 v[64:67], a[0:3], v[144:147], 0
    buffer_load_dwordx4 v[120:123], v16, s[36:39], s53 offen offset:0 sc1
    v_mfma_f32_16x16x32_bf16 v[68:71], a[4:7], v[144:147], 0
    v_mfma_f32_16x16x32_bf16 v[72:75], a[8:11], v[144:147], 0
    v_mfma_f32_16x16x32_bf16 v[76:79], a[12:15], v[144:147], 0
    s_waitcnt vmcnt(9)
    v_mfma_f32_16x16x32_bf16 v[76:79], a[28:31], v[148:151], v[76:79]
    buffer_load_dwordx4 v[124:127], v16, s[36:39], s53 offen offset:1024 sc1
    v_mfma_f32_16x16x32_bf16 v[72:75], a[24:27], v[148:151], v[72:75]
    ds_write_b128 v24, v[48:51] offset:4096
    v_mfma_f32_16x16x32_bf16 v[68:71], a[20:23], v[148:151], v[68:71]
    ds_write_b128 v25, v[52:55] offset:4096
    v_mfma_f32_16x16x32_bf16 v[64:67], a[16:19], v[148:151], v[64:67]
    s_waitcnt vmcnt(9)
    v_mfma_f32_16x16x32_bf16 v[64:67], a[32:35], v[152:155], v[64:67]
    buffer_load_dwordx4 v[128:131], v16, s[36:39], s54 offen offset:0 sc1
    v_mfma_f32_16x16x32_bf16 v[68:71], a[36:39], v[152:155], v[68:71]
    ds_write_b128 v24, v[56:59] offset:4224
    v_mfma_f32_16x16x32_bf16 v[72:75], a[40:43], v[152:155], v[72:75]
    ds_write_b128 v25, v[60:63] offset:4224
    v_mfma_f32_16x16x32_bf16 v[76:79], a[44:47], v[152:155], v[76:79]
    s_waitcnt vmcnt(9)
    v_mfma_f32_16x16x32_bf16 v[76:79], a[60:63], v[156:159], v[76:79]
    buffer_load_dwordx4 v[132:135], v16, s[36:39], s54 offen offset:1024 sc1
    v_mfma_f32_16x16x32_bf16 v[72:75], a[56:59], v[156:159], v[72:75]
    v_mfma_f32_16x16x32_bf16 v[68:71], a[52:55], v[156:159], v[68:71]
    v_mfma_f32_16x16x32_bf16 v[64:67], a[48:51], v[156:159], v[64:67]
    s_waitcnt vmcnt(9)
    v_mfma_f32_16x16x32_bf16 v[64:67], a[64:67], v[96:99], v[64:67]
    buffer_load_dwordx4 v[136:139], v17, s[36:39], s48 offen offset:0 sc1
    v_mfma_f32_16x16x32_bf16 v[68:71], a[68:71], v[96:99], v[68:71]
    s_waitcnt lgkmcnt(0)
    v_mfma_f32_16x16x32_bf16 v[72:75], a[72:75], v[96:99], v[72:75]
    s_barrier
    v_mfma_f32_16x16x32_bf16 v[76:79], a[76:79], v[96:99], v[76:79]
    s_waitcnt vmcnt(9)
    v_mfma_f32_16x16x32_bf16 v[76:79], a[92:95], v[100:103], v[76:79]
    buffer_load_dwordx4 v[140:143], v17, s[36:39], s48 offen offset:1024 sc1
    v_mfma_f32_16x16x32_bf16 v[72:75], a[88:91], v[100:103], v[72:75]
    ds_read_b128 v[232:235], v26 offset:4096
    ds_read_b128 v[236:239], v26 offset:12288
    v_mfma_f32_16x16x32_bf16 v[68:71], a[84:87], v[100:103], v[68:71]
    ds_read_b128 v[240:243], v26 offset:20480
    ds_read_b128 v[244:247], v26 offset:28672
    v_mfma_f32_16x16x32_bf16 v[64:67], a[80:83], v[100:103], v[64:67]
    s_waitcnt vmcnt(9)
    v_mfma_f32_16x16x32_bf16 v[64:67], a[96:99], v[104:107], v[64:67]
    buffer_load_dwordx4 v[144:147], v17, s[36:39], s49 offen offset:0 sc1
    v_mfma_f32_16x16x32_bf16 v[68:71], a[100:103], v[104:107], v[68:71]
    v_mfma_f32_16x16x32_bf16 v[72:75], a[104:107], v[104:107], v[72:75]
    v_mfma_f32_16x16x32_bf16 v[76:79], a[108:111], v[104:107], v[76:79]
    s_waitcnt vmcnt(9)
    v_mfma_f32_16x16x32_bf16 v[76:79], a[124:127], v[108:111], v[76:79]
    buffer_load_dwordx4 v[148:151], v17, s[36:39], s49 offen offset:1024 sc1
    v_mfma_f32_16x16x32_bf16 v[72:75], a[120:123], v[108:111], v[72:75]
    s_waitcnt lgkmcnt(0)
    v_add_f32 v232, v232, v236
    v_mfma_f32_16x16x32_bf16 v[68:71], a[116:119], v[108:111], v[68:71]
    v_add_f32 v233, v233, v237
    v_add_f32 v234, v234, v238
    v_mfma_f32_16x16x32_bf16 v[64:67], a[112:115], v[108:111], v[64:67]
    s_waitcnt vmcnt(9)
    v_mfma_f32_16x16x32_bf16 v[64:67], a[128:131], v[112:115], v[64:67]
    buffer_load_dwordx4 v[152:155], v17, s[36:39], s50 offen offset:0 sc1
    v_mfma_f32_16x16x32_bf16 v[68:71], a[132:135], v[112:115], v[68:71]
    v_add_f32 v235, v235, v239
    v_add_f32 v240, v240, v244
    v_mfma_f32_16x16x32_bf16 v[72:75], a[136:139], v[112:115], v[72:75]
    v_add_f32 v241, v241, v245
    v_add_f32 v242, v242, v246
    v_mfma_f32_16x16x32_bf16 v[76:79], a[140:143], v[112:115], v[76:79]
    s_waitcnt vmcnt(9)
    v_mfma_f32_16x16x32_bf16 v[76:79], a[156:159], v[116:119], v[76:79]
    buffer_load_dwordx4 v[156:159], v17, s[36:39], s50 offen offset:1024 sc1
    v_mfma_f32_16x16x32_bf16 v[72:75], a[152:155], v[116:119], v[72:75]
    v_add_f32 v243, v243, v247
    v_add_f32 v232, v232, v240
    v_mfma_f32_16x16x32_bf16 v[68:71], a[148:151], v[116:119], v[68:71]
    v_add_f32 v233, v233, v241
    v_add_f32 v234, v234, v242
    v_mfma_f32_16x16x32_bf16 v[64:67], a[144:147], v[116:119], v[64:67]
    s_waitcnt vmcnt(9)
    v_mfma_f32_16x16x32_bf16 v[64:67], a[160:163], v[120:123], v[64:67]
    buffer_load_dwordx4 v[96:99], v17, s[36:39], s51 offen offset:0 sc1
    v_mfma_f32_16x16x32_bf16 v[68:71], a[164:167], v[120:123], v[68:71]
    v_add_f32 v235, v235, v243
    v_mfma_f32_16x16x32_bf16 v[72:75], a[168:171], v[120:123], v[72:75]
    v_cvt_pk_bf16_f32 v224, v232, v233
    v_mfma_f32_16x16x32_bf16 v[76:79], a[172:175], v[120:123], v[76:79]
    v_cvt_pk_bf16_f32 v225, v234, v235
    s_waitcnt vmcnt(9)
    v_mfma_f32_16x16x32_bf16 v[76:79], a[188:191], v[124:127], v[76:79]
    buffer_load_dwordx4 v[100:103], v17, s[36:39], s51 offen offset:1024 sc1
    v_mfma_f32_16x16x32_bf16 v[72:75], a[184:187], v[124:127], v[72:75]
    v_mfma_f32_16x16x32_bf16 v[68:71], a[180:183], v[124:127], v[68:71]
    v_mfma_f32_16x16x32_bf16 v[64:67], a[176:179], v[124:127], v[64:67]
    s_waitcnt vmcnt(9)
    v_mfma_f32_16x16x32_bf16 v[64:67], a[192:195], v[128:131], v[64:67]
    buffer_load_dwordx4 v[104:107], v17, s[36:39], s52 offen offset:0 sc1
    v_mfma_f32_16x16x32_bf16 v[68:71], a[196:199], v[128:131], v[68:71]
    v_mfma_f32_16x16x32_bf16 v[72:75], a[200:203], v[128:131], v[72:75]
    v_mfma_f32_16x16x32_bf16 v[76:79], a[204:207], v[128:131], v[76:79]
    s_waitcnt vmcnt(9)
    v_mfma_f32_16x16x32_bf16 v[76:79], a[220:223], v[132:135], v[76:79]
    buffer_load_dwordx4 v[108:111], v17, s[36:39], s52 offen offset:1024 sc1
    v_mfma_f32_16x16x32_bf16 v[72:75], a[216:219], v[132:135], v[72:75]
    v_mfma_f32_16x16x32_bf16 v[68:71], a[212:215], v[132:135], v[68:71]
    v_mfma_f32_16x16x32_bf16 v[64:67], a[208:211], v[132:135], v[64:67]
    s_waitcnt vmcnt(9)
    v_mfma_f32_16x16x32_bf16 v[80:83], a[0:3], v[136:139], 0
    buffer_load_dwordx4 v[112:115], v17, s[36:39], s53 offen offset:0 sc1
    v_mfma_f32_16x16x32_bf16 v[84:87], a[4:7], v[136:139], 0
    v_mfma_f32_16x16x32_bf16 v[88:91], a[8:11], v[136:139], 0
    v_mfma_f32_16x16x32_bf16 v[92:95], a[12:15], v[136:139], 0
    s_waitcnt vmcnt(9)
    v_mfma_f32_16x16x32_bf16 v[92:95], a[28:31], v[140:143], v[92:95]
    buffer_load_dwordx4 v[116:119], v17, s[36:39], s53 offen offset:1024 sc1
    v_mfma_f32_16x16x32_bf16 v[88:91], a[24:27], v[140:143], v[88:91]
    ds_write_b128 v24, v[64:67] offset:32768
    v_mfma_f32_16x16x32_bf16 v[84:87], a[20:23], v[140:143], v[84:87]
    ds_write_b128 v25, v[68:71] offset:32768
    v_mfma_f32_16x16x32_bf16 v[80:83], a[16:19], v[140:143], v[80:83]
    s_waitcnt vmcnt(9)
    v_mfma_f32_16x16x32_bf16 v[80:83], a[32:35], v[144:147], v[80:83]
    buffer_load_dwordx4 v[120:123], v17, s[36:39], s54 offen offset:0 sc1
    v_mfma_f32_16x16x32_bf16 v[84:87], a[36:39], v[144:147], v[84:87]
    ds_write_b128 v24, v[72:75] offset:32896
    v_mfma_f32_16x16x32_bf16 v[88:91], a[40:43], v[144:147], v[88:91]
    ds_write_b128 v25, v[76:79] offset:32896
    v_mfma_f32_16x16x32_bf16 v[92:95], a[44:47], v[144:147], v[92:95]
    s_waitcnt vmcnt(9)
    v_mfma_f32_16x16x32_bf16 v[92:95], a[60:63], v[148:151], v[92:95]
    buffer_load_dwordx4 v[124:127], v17, s[36:39], s54 offen offset:1024 sc1
    v_mfma_f32_16x16x32_bf16 v[88:91], a[56:59], v[148:151], v[88:91]
    v_mfma_f32_16x16x32_bf16 v[84:87], a[52:55], v[148:151], v[84:87]
    v_mfma_f32_16x16x32_bf16 v[80:83], a[48:51], v[148:151], v[80:83]
    s_waitcnt vmcnt(9)
    v_mfma_f32_16x16x32_bf16 v[80:83], a[64:67], v[152:155], v[80:83]
    buffer_store_dwordx2 v[222:223], v23, s[28:31], s43 offen sc1
    v_mfma_f32_16x16x32_bf16 v[84:87], a[68:71], v[152:155], v[84:87]
    buffer_store_dwordx2 v[224:225], v23, s[28:31], s44 offen sc1
    v_mfma_f32_16x16x32_bf16 v[88:91], a[72:75], v[152:155], v[88:91]
    s_waitcnt lgkmcnt(0)
    v_mfma_f32_16x16x32_bf16 v[92:95], a[76:79], v[152:155], v[92:95]
    s_barrier
    s_waitcnt vmcnt(10)
    v_mfma_f32_16x16x32_bf16 v[92:95], a[92:95], v[156:159], v[92:95]
    ds_read_b128 v[232:235], v26 offset:32768
    v_mfma_f32_16x16x32_bf16 v[88:91], a[88:91], v[156:159], v[88:91]
    ds_read_b128 v[236:239], v26 offset:40960
    v_mfma_f32_16x16x32_bf16 v[84:87], a[84:87], v[156:159], v[84:87]
    ds_read_b128 v[240:243], v26 offset:49152
    v_mfma_f32_16x16x32_bf16 v[80:83], a[80:83], v[156:159], v[80:83]
    ds_read_b128 v[244:247], v26 offset:57344
    s_waitcnt vmcnt(9)
    v_mfma_f32_16x16x32_bf16 v[80:83], a[96:99], v[96:99], v[80:83]
    v_mfma_f32_16x16x32_bf16 v[84:87], a[100:103], v[96:99], v[84:87]
    v_mfma_f32_16x16x32_bf16 v[88:91], a[104:107], v[96:99], v[88:91]
    v_mfma_f32_16x16x32_bf16 v[92:95], a[108:111], v[96:99], v[92:95]
    s_waitcnt vmcnt(8)
    v_mfma_f32_16x16x32_bf16 v[92:95], a[124:127], v[100:103], v[92:95]
    s_waitcnt lgkmcnt(0)
    v_mfma_f32_16x16x32_bf16 v[88:91], a[120:123], v[100:103], v[88:91]
    v_add_f32 v232, v232, v236
    v_mfma_f32_16x16x32_bf16 v[84:87], a[116:119], v[100:103], v[84:87]
    v_add_f32 v233, v233, v237
    v_mfma_f32_16x16x32_bf16 v[80:83], a[112:115], v[100:103], v[80:83]
    v_add_f32 v234, v234, v238
    s_waitcnt vmcnt(7)
    v_mfma_f32_16x16x32_bf16 v[80:83], a[128:131], v[104:107], v[80:83]
    v_add_f32 v235, v235, v239
    v_mfma_f32_16x16x32_bf16 v[84:87], a[132:135], v[104:107], v[84:87]
    v_add_f32 v240, v240, v244
    v_mfma_f32_16x16x32_bf16 v[88:91], a[136:139], v[104:107], v[88:91]
    v_add_f32 v241, v241, v245
    v_mfma_f32_16x16x32_bf16 v[92:95], a[140:143], v[104:107], v[92:95]
    v_add_f32 v242, v242, v246
    s_waitcnt vmcnt(6)
    v_mfma_f32_16x16x32_bf16 v[92:95], a[156:159], v[108:111], v[92:95]
    v_add_f32 v243, v243, v247
    v_mfma_f32_16x16x32_bf16 v[88:91], a[152:155], v[108:111], v[88:91]
    v_add_f32 v232, v232, v240
    v_mfma_f32_16x16x32_bf16 v[84:87], a[148:151], v[108:111], v[84:87]
    v_add_f32 v233, v233, v241
    v_mfma_f32_16x16x32_bf16 v[80:83], a[144:147], v[108:111], v[80:83]
    v_add_f32 v234, v234, v242
    s_waitcnt vmcnt(5)
    v_mfma_f32_16x16x32_bf16 v[80:83], a[160:163], v[112:115], v[80:83]
    v_add_f32 v235, v235, v243
    v_mfma_f32_16x16x32_bf16 v[84:87], a[164:167], v[112:115], v[84:87]
    v_cvt_pk_bf16_f32 v226, v232, v233
    v_mfma_f32_16x16x32_bf16 v[88:91], a[168:171], v[112:115], v[88:91]
    v_cvt_pk_bf16_f32 v227, v234, v235
    v_mfma_f32_16x16x32_bf16 v[92:95], a[172:175], v[112:115], v[92:95]
    s_waitcnt vmcnt(4)
    v_mfma_f32_16x16x32_bf16 v[92:95], a[188:191], v[116:119], v[92:95]
    buffer_store_dwordx2 v[226:227], v23, s[28:31], s45 offen sc1
    v_mfma_f32_16x16x32_bf16 v[88:91], a[184:187], v[116:119], v[88:91]
    v_mfma_f32_16x16x32_bf16 v[84:87], a[180:183], v[116:119], v[84:87]
    v_mfma_f32_16x16x32_bf16 v[80:83], a[176:179], v[116:119], v[80:83]
    s_waitcnt vmcnt(4)
    v_mfma_f32_16x16x32_bf16 v[80:83], a[192:195], v[120:123], v[80:83]
    v_mfma_f32_16x16x32_bf16 v[84:87], a[196:199], v[120:123], v[84:87]
    v_mfma_f32_16x16x32_bf16 v[88:91], a[200:203], v[120:123], v[88:91]
    v_mfma_f32_16x16x32_bf16 v[92:95], a[204:207], v[120:123], v[92:95]
    s_waitcnt vmcnt(3)
    v_mfma_f32_16x16x32_bf16 v[92:95], a[220:223], v[124:127], v[92:95]
    v_mfma_f32_16x16x32_bf16 v[88:91], a[216:219], v[124:127], v[88:91]
    v_mfma_f32_16x16x32_bf16 v[84:87], a[212:215], v[124:127], v[84:87]
    v_mfma_f32_16x16x32_bf16 v[80:83], a[208:211], v[124:127], v[80:83]
    s_nop 4
    ds_write_b128 v25, v[92:95] offset:36992
    ds_write_b128 v24, v[88:91] offset:36992
    ds_write_b128 v25, v[84:87] offset:36864
    ds_write_b128 v24, v[80:83] offset:36864
    s_waitcnt lgkmcnt(0)
    s_barrier
    ds_read_b128 v[232:235], v26 offset:36864
    ds_read_b128 v[236:239], v26 offset:45056
    ds_read_b128 v[240:243], v26 offset:53248
    ds_read_b128 v[244:247], v26 offset:61440
    s_waitcnt lgkmcnt(2)
    v_pk_add_f32 v[232:233], v[232:233], v[236:237]
    v_pk_add_f32 v[234:235], v[234:235], v[238:239]
    s_waitcnt lgkmcnt(0)
    v_pk_add_f32 v[240:241], v[240:241], v[244:245]
    v_pk_add_f32 v[242:243], v[242:243], v[246:247]
    v_pk_add_f32 v[232:233], v[232:233], v[240:241]
    v_pk_add_f32 v[234:235], v[234:235], v[242:243]
    v_cvt_pk_bf16_f32 v228, v232, v233
    v_cvt_pk_bf16_f32 v229, v234, v235
    buffer_store_dwordx2 v[228:229], v23, s[28:31], s46 offen sc1
L_end:
    s_endpgm
L_early_idle:
    v_lshrrev_b32 v36, 2, v1
    v_and_b32 v37, 1, v1
    v_bfe_u32 v38, v1, 1, 1
    v_lshl_add_u32 v37, v38, 2, v37
    v_lshlrev_b32 v37, 7, v37
    v_lshl_add_u32 v36, v36, 10, v37
    s_and_b32 s49, s41, 6
    s_lshl_b32 s49, s49, 1
    s_add_u32 s49, s49, s3
    s_lshl_b32 s49, s49, 1
    s_and_b32 s50, s41, 1
    s_add_u32 s49, s49, s50
    s_lshl_b32 s49, s49, 2
    s_add_u32 s49, s49, s40
    s_lshl_b32 s49, s49, 14
    v_mul_u32_u24 v37, 4682, v1
    v_lshrrev_b32 v37, 16, v37
    v_mul_u32_u24 v38, 14, v37
    v_sub_u32 v38, v1, v38
    v_lshlrev_b32 v38, 7, v38
    v_and_b32 v39, 1, v37
    v_lshrrev_b32 v37, 1, v37
    v_lshl_add_u32 v37, v37, 8, v39
    v_mul_u32_u24 v37, 3584, v37
    v_add_u32 v37, v37, v38
    s_mul_i32 s50, s50, 1792
    s_lshr_b32 s51, s41, 1
    s_lshl_b32 s51, s51, 2
    s_add_u32 s51, s51, s3
    s_lshl_b32 s51, s51, 2
    s_add_u32 s51, s51, s40
    s_lshl_b32 s51, s51, 1
    s_add_u32 s51, s51, 128
    s_mul_i32 s51, s51, 3584
    s_add_u32 s50, s50, s51
    s_mov_b32 exec_hi, 0xffffff
    buffer_load_dword v92, v37, s[20:23], s50 offen
    s_mov_b32 exec_hi, -1
    buffer_load_dword v93, v36, s[16:19], s49 offen offset:256
    s_mov_b32 s24, s8
    s_mov_b32 s25, s9
    s_mov_b32 s26, 0x1c0000
    s_mov_b32 s27, 0x20000
    v_lshlrev_b32 v40, 7, v1
    s_lshl_b32 s49, s3, 3
    s_add_u32 s49, s49, s41
    s_lshl_b32 s49, s49, 2
    s_add_u32 s49, s49, s40
    s_mul_i32 s49, s49, 14336
    s_add_u32 s50, s49, 8192
    buffer_load_dword v94, v40, s[24:27], s49 offen
    s_mov_b32 exec_hi, 0xffff
    buffer_load_dword v95, v40, s[24:27], s50 offen
    s_mov_b32 exec_hi, -1
    s_branch L_setup2
L_idle:
    s_mul_i32 s4, s40, 7
    s_lshl_b32 s5, s3, 1
    s_add_u32 s5, s5, 0
    s_cmp_ge_u32 s5, 7
    s_cselect_b32 s6, 7, 0
    s_sub_u32 s5, s5, s6
    s_add_u32 s5, s5, s4
    s_lshl_b32 s56, s5, 16
    s_lshl_b32 s48, s5, 11
    s_lshl_b32 s5, s3, 1
    s_add_u32 s5, s5, 1
    s_cmp_ge_u32 s5, 7
    s_cselect_b32 s6, 7, 0
    s_sub_u32 s5, s5, s6
    s_add_u32 s5, s5, s4
    s_lshl_b32 s61, s5, 16
    s_lshl_b32 s53, s5, 11
    s_lshl_b32 s5, s3, 1
    s_add_u32 s5, s5, 2
    s_cmp_ge_u32 s5, 7
    s_cselect_b32 s6, 7, 0
    s_sub_u32 s5, s5, s6
    s_add_u32 s5, s5, s4
    s_lshl_b32 s62, s5, 16
    s_lshl_b32 s54, s5, 11
    s_lshl_b32 s5, s3, 1
    s_add_u32 s5, s5, 3
    s_cmp_ge_u32 s5, 7
    s_cselect_b32 s6, 7, 0
    s_sub_u32 s5, s5, s6
    s_add_u32 s5, s5, s4
    s_lshl_b32 s57, s5, 16
    s_lshl_b32 s49, s5, 11
    s_lshl_b32 s5, s3, 1
    s_add_u32 s5, s5, 4
    s_cmp_ge_u32 s5, 7
    s_cselect_b32 s6, 7, 0
    s_sub_u32 s5, s5, s6
    s_add_u32 s5, s5, s4
    s_lshl_b32 s58, s5, 16
    s_lshl_b32 s50, s5, 11
    s_lshl_b32 s5, s3, 1
    s_add_u32 s5, s5, 5
    s_cmp_ge_u32 s5, 7
    s_cselect_b32 s6, 7, 0
    s_sub_u32 s5, s5, s6
    s_add_u32 s5, s5, s4
    s_lshl_b32 s59, s5, 16
    s_lshl_b32 s51, s5, 11
    s_lshl_b32 s5, s3, 1
    s_add_u32 s5, s5, 6
    s_cmp_ge_u32 s5, 7
    s_cselect_b32 s6, 7, 0
    s_sub_u32 s5, s5, s6
    s_add_u32 s5, s5, s4
    s_lshl_b32 s60, s5, 16
    s_lshl_b32 s52, s5, 11
    buffer_load_dwordx2 v[20:21], v18, s[32:35], 0 offen sc1
    s_add_u32 m0, s55, 0
    s_nop 0
    buffer_load_dwordx4 v10, s[24:27], s56 offen offset:0 lds
    buffer_load_dwordx4 v11, s[24:27], s56 offen offset:1024 lds
    buffer_load_dwordx4 v12, s[24:27], s56 offen offset:2048 lds
    buffer_load_dwordx4 v13, s[24:27], s56 offen offset:3072 lds
    s_add_u32 m0, s55, 4096
    s_add_u32 s46, s56, 32768
    buffer_load_dwordx4 v10, s[24:27], s46 offen offset:0 lds
    buffer_load_dwordx4 v11, s[24:27], s46 offen offset:1024 lds
    buffer_load_dwordx4 v12, s[24:27], s46 offen offset:2048 lds
    buffer_load_dwordx4 v13, s[24:27], s46 offen offset:3072 lds
    s_add_u32 m0, s55, 32768
    s_nop 0
    buffer_load_dwordx4 v10, s[24:27], s61 offen offset:0 lds
    buffer_load_dwordx4 v11, s[24:27], s61 offen offset:1024 lds
    buffer_load_dwordx4 v12, s[24:27], s61 offen offset:2048 lds
    buffer_load_dwordx4 v13, s[24:27], s61 offen offset:3072 lds
    s_add_u32 m0, s55, 36864
    s_add_u32 s46, s61, 32768
    buffer_load_dwordx4 v10, s[24:27], s46 offen offset:0 lds
    buffer_load_dwordx4 v11, s[24:27], s46 offen offset:1024 lds
    buffer_load_dwordx4 v12, s[24:27], s46 offen offset:2048 lds
    buffer_load_dwordx4 v13, s[24:27], s46 offen offset:3072 lds
    s_add_u32 m0, s55, 65536
    s_nop 0
    buffer_load_dwordx4 v10, s[24:27], s62 offen offset:0 lds
    buffer_load_dwordx4 v11, s[24:27], s62 offen offset:1024 lds
    buffer_load_dwordx4 v12, s[24:27], s62 offen offset:2048 lds
    buffer_load_dwordx4 v13, s[24:27], s62 offen offset:3072 lds
    s_add_u32 m0, s55, 69632
    s_add_u32 s46, s62, 32768
    buffer_load_dwordx4 v10, s[24:27], s46 offen offset:0 lds
    buffer_load_dwordx4 v11, s[24:27], s46 offen offset:1024 lds
    buffer_load_dwordx4 v12, s[24:27], s46 offen offset:2048 lds
    buffer_load_dwordx4 v13, s[24:27], s46 offen offset:3072 lds
    s_waitcnt vmcnt(16) lgkmcnt(4)
    ds_read_b64_tr_b16 a[0:1], v210 offset:0
    ds_read_b64_tr_b16 a[2:3], v210 offset:2048
    ds_read_b64_tr_b16 a[4:5], v211 offset:0
    ds_read_b64_tr_b16 a[6:7], v211 offset:2048
    ds_read_b64_tr_b16 a[8:9], v212 offset:0
    ds_read_b64_tr_b16 a[10:11], v212 offset:2048
    ds_read_b64_tr_b16 a[12:13], v213 offset:0
    ds_read_b64_tr_b16 a[14:15], v213 offset:2048
    s_waitcnt lgkmcnt(4)
    ds_read_b64_tr_b16 a[16:17], v210 offset:4096
    ds_read_b64_tr_b16 a[18:19], v210 offset:6144
    ds_read_b64_tr_b16 a[20:21], v211 offset:4096
    ds_read_b64_tr_b16 a[22:23], v211 offset:6144
    ds_read_b64_tr_b16 a[24:25], v212 offset:4096
    ds_read_b64_tr_b16 a[26:27], v212 offset:6144
    ds_read_b64_tr_b16 a[28:29], v213 offset:4096
    ds_read_b64_tr_b16 a[30:31], v213 offset:6144
    s_add_u32 m0, s55, 98304
    s_nop 0
    buffer_load_dwordx4 v10, s[24:27], s57 offen offset:0 lds
    buffer_load_dwordx4 v11, s[24:27], s57 offen offset:1024 lds
    buffer_load_dwordx4 v12, s[24:27], s57 offen offset:2048 lds
    buffer_load_dwordx4 v13, s[24:27], s57 offen offset:3072 lds
    s_add_u32 m0, s55, 102400
    s_add_u32 s46, s57, 32768
    buffer_load_dwordx4 v10, s[24:27], s46 offen offset:0 lds
    buffer_load_dwordx4 v11, s[24:27], s46 offen offset:1024 lds
    buffer_load_dwordx4 v12, s[24:27], s46 offen offset:2048 lds
    buffer_load_dwordx4 v13, s[24:27], s46 offen offset:3072 lds
    s_waitcnt vmcnt(16) lgkmcnt(4)
    ds_read_b64_tr_b16 a[160:161], v210 offset:32768
    ds_read_b64_tr_b16 a[162:163], v210 offset:34816
    ds_read_b64_tr_b16 a[164:165], v211 offset:32768
    ds_read_b64_tr_b16 a[166:167], v211 offset:34816
    ds_read_b64_tr_b16 a[168:169], v212 offset:32768
    ds_read_b64_tr_b16 a[170:171], v212 offset:34816
    ds_read_b64_tr_b16 a[172:173], v213 offset:32768
    ds_read_b64_tr_b16 a[174:175], v213 offset:34816
    s_waitcnt lgkmcnt(4)
    ds_read_b64_tr_b16 a[176:177], v210 offset:36864
    ds_read_b64_tr_b16 a[178:179], v210 offset:38912
    ds_read_b64_tr_b16 a[180:181], v211 offset:36864
    ds_read_b64_tr_b16 a[182:183], v211 offset:38912
    ds_read_b64_tr_b16 a[184:185], v212 offset:36864
    ds_read_b64_tr_b16 a[186:187], v212 offset:38912
    ds_read_b64_tr_b16 a[188:189], v213 offset:36864
    ds_read_b64_tr_b16 a[190:191], v213 offset:38912
    s_add_u32 m0, s55, 131072
    s_nop 0
    buffer_load_dwordx4 v10, s[24:27], s58 offen offset:0 lds
    buffer_load_dwordx4 v11, s[24:27], s58 offen offset:1024 lds
    buffer_load_dwordx4 v12, s[24:27], s58 offen offset:2048 lds
    buffer_load_dwordx4 v13, s[24:27], s58 offen offset:3072 lds
    s_add_u32 m0, s55, 135168
    s_add_u32 s46, s58, 32768
    buffer_load_dwordx4 v10, s[24:27], s46 offen offset:0 lds
    buffer_load_dwordx4 v11, s[24:27], s46 offen offset:1024 lds
    buffer_load_dwordx4 v12, s[24:27], s46 offen offset:2048 lds
    buffer_load_dwordx4 v13, s[24:27], s46 offen offset:3072 lds
    s_waitcnt vmcnt(16) lgkmcnt(4)
    ds_read_b64_tr_b16 a[192:193], v214 offset:0
    ds_read_b64_tr_b16 a[194:195], v214 offset:2048
    ds_read_b64_tr_b16 a[196:197], v215 offset:0
    ds_read_b64_tr_b16 a[198:199], v215 offset:2048
    ds_read_b64_tr_b16 a[200:201], v216 offset:0
    ds_read_b64_tr_b16 a[202:203], v216 offset:2048
    ds_read_b64_tr_b16 a[204:205], v217 offset:0
    ds_read_b64_tr_b16 a[206:207], v217 offset:2048
    s_waitcnt lgkmcnt(4)
    ds_read_b64_tr_b16 a[208:209], v214 offset:4096
    ds_read_b64_tr_b16 a[210:211], v214 offset:6144
    ds_read_b64_tr_b16 a[212:213], v215 offset:4096
    ds_read_b64_tr_b16 a[214:215], v215 offset:6144
    ds_read_b64_tr_b16 a[216:217], v216 offset:4096
    ds_read_b64_tr_b16 a[218:219], v216 offset:6144
    ds_read_b64_tr_b16 a[220:221], v217 offset:4096
    ds_read_b64_tr_b16 a[222:223], v217 offset:6144
    s_add_u32 m0, s55, 0
    s_nop 0
    buffer_load_dwordx4 v10, s[24:27], s59 offen offset:0 lds
    buffer_load_dwordx4 v11, s[24:27], s59 offen offset:1024 lds
    buffer_load_dwordx4 v12, s[24:27], s59 offen offset:2048 lds
    buffer_load_dwordx4 v13, s[24:27], s59 offen offset:3072 lds
    s_add_u32 m0, s55, 4096
    s_add_u32 s46, s59, 32768
    buffer_load_dwordx4 v10, s[24:27], s46 offen offset:0 lds
    buffer_load_dwordx4 v11, s[24:27], s46 offen offset:1024 lds
    buffer_load_dwordx4 v12, s[24:27], s46 offen offset:2048 lds
    buffer_load_dwordx4 v13, s[24:27], s46 offen offset:3072 lds
    s_waitcnt vmcnt(16) lgkmcnt(4)
    ds_read_b64_tr_b16 a[32:33], v214 offset:32768
    ds_read_b64_tr_b16 a[34:35], v214 offset:34816
    ds_read_b64_tr_b16 a[36:37], v215 offset:32768
    ds_read_b64_tr_b16 a[38:39], v215 offset:34816
    ds_read_b64_tr_b16 a[40:41], v216 offset:32768
    ds_read_b64_tr_b16 a[42:43], v216 offset:34816
    ds_read_b64_tr_b16 a[44:45], v217 offset:32768
    ds_read_b64_tr_b16 a[46:47], v217 offset:34816
    s_waitcnt lgkmcnt(4)
    ds_read_b64_tr_b16 a[48:49], v214 offset:36864
    ds_read_b64_tr_b16 a[50:51], v214 offset:38912
    ds_read_b64_tr_b16 a[52:53], v215 offset:36864
    ds_read_b64_tr_b16 a[54:55], v215 offset:38912
    ds_read_b64_tr_b16 a[56:57], v216 offset:36864
    ds_read_b64_tr_b16 a[58:59], v216 offset:38912
    ds_read_b64_tr_b16 a[60:61], v217 offset:36864
    ds_read_b64_tr_b16 a[62:63], v217 offset:38912
    s_add_u32 m0, s55, 32768
    s_nop 0
    buffer_load_dwordx4 v10, s[24:27], s60 offen offset:0 lds
    buffer_load_dwordx4 v11, s[24:27], s60 offen offset:1024 lds
    buffer_load_dwordx4 v12, s[24:27], s60 offen offset:2048 lds
    buffer_load_dwordx4 v13, s[24:27], s60 offen offset:3072 lds
    s_add_u32 m0, s55, 36864
    s_add_u32 s46, s60, 32768
    buffer_load_dwordx4 v10, s[24:27], s46 offen offset:0 lds
    buffer_load_dwordx4 v11, s[24:27], s46 offen offset:1024 lds
    buffer_load_dwordx4 v12, s[24:27], s46 offen offset:2048 lds
    buffer_load_dwordx4 v13, s[24:27], s46 offen offset:3072 lds
    s_waitcnt vmcnt(16) lgkmcnt(4)
    ds_read_b64_tr_b16 a[64:65], v218 offset:0
    ds_read_b64_tr_b16 a[66:67], v218 offset:2048
    ds_read_b64_tr_b16 a[68:69], v219 offset:0
    ds_read_b64_tr_b16 a[70:71], v219 offset:2048
    ds_read_b64_tr_b16 a[72:73], v220 offset:0
    ds_read_b64_tr_b16 a[74:75], v220 offset:2048
    ds_read_b64_tr_b16 a[76:77], v221 offset:0
    ds_read_b64_tr_b16 a[78:79], v221 offset:2048
    s_waitcnt lgkmcnt(4)
    ds_read_b64_tr_b16 a[80:81], v218 offset:4096
    ds_read_b64_tr_b16 a[82:83], v218 offset:6144
    ds_read_b64_tr_b16 a[84:85], v219 offset:4096
    ds_read_b64_tr_b16 a[86:87], v219 offset:6144
    ds_read_b64_tr_b16 a[88:89], v220 offset:4096
    ds_read_b64_tr_b16 a[90:91], v220 offset:6144
    ds_read_b64_tr_b16 a[92:93], v221 offset:4096
    ds_read_b64_tr_b16 a[94:95], v221 offset:6144
    s_waitcnt vmcnt(8) lgkmcnt(4)
    ds_read_b64_tr_b16 a[96:97], v210 offset:0
    ds_read_b64_tr_b16 a[98:99], v210 offset:2048
    ds_read_b64_tr_b16 a[100:101], v211 offset:0
    ds_read_b64_tr_b16 a[102:103], v211 offset:2048
    ds_read_b64_tr_b16 a[104:105], v212 offset:0
    ds_read_b64_tr_b16 a[106:107], v212 offset:2048
    ds_read_b64_tr_b16 a[108:109], v213 offset:0
    ds_read_b64_tr_b16 a[110:111], v213 offset:2048
    s_waitcnt lgkmcnt(4)
    ds_read_b64_tr_b16 a[112:113], v210 offset:4096
    ds_read_b64_tr_b16 a[114:115], v210 offset:6144
    ds_read_b64_tr_b16 a[116:117], v211 offset:4096
    ds_read_b64_tr_b16 a[118:119], v211 offset:6144
    ds_read_b64_tr_b16 a[120:121], v212 offset:4096
    ds_read_b64_tr_b16 a[122:123], v212 offset:6144
    ds_read_b64_tr_b16 a[124:125], v213 offset:4096
    ds_read_b64_tr_b16 a[126:127], v213 offset:6144
    s_waitcnt vmcnt(0) lgkmcnt(4)
    ds_read_b64_tr_b16 a[128:129], v210 offset:32768
    ds_read_b64_tr_b16 a[130:131], v210 offset:34816
    ds_read_b64_tr_b16 a[132:133], v211 offset:32768
    ds_read_b64_tr_b16 a[134:135], v211 offset:34816
    ds_read_b64_tr_b16 a[136:137], v212 offset:32768
    ds_read_b64_tr_b16 a[138:139], v212 offset:34816
    ds_read_b64_tr_b16 a[140:141], v213 offset:32768
    ds_read_b64_tr_b16 a[142:143], v213 offset:34816
    s_waitcnt lgkmcnt(4)
    ds_read_b64_tr_b16 a[144:145], v210 offset:36864
    ds_read_b64_tr_b16 a[146:147], v210 offset:38912
    ds_read_b64_tr_b16 a[148:149], v211 offset:36864
    ds_read_b64_tr_b16 a[150:151], v211 offset:38912
    ds_read_b64_tr_b16 a[152:153], v212 offset:36864
    ds_read_b64_tr_b16 a[154:155], v212 offset:38912
    ds_read_b64_tr_b16 a[156:157], v213 offset:36864
    ds_read_b64_tr_b16 a[158:159], v213 offset:38912
    v_readfirstlane_b32 s81, v21
    s_mov_b32 s63, 0x40000
L_non_i:
    s_cmp_lg_u32 s81, 0
    s_cbranch_scc1 L_nonok_i
    buffer_load_dwordx2 v[20:21], v18, s[32:35], 0 offen sc1
    s_waitcnt vmcnt(0)
    v_readfirstlane_b32 s81, v21
    s_sub_u32 s63, s63, 1
    s_cbranch_scc0 L_non_i
L_nonok_i:
    v_readfirstlane_b32 s80, v20
    s_mov_b32 s63, 0x40000
L_poll_I:
    s_load_dwordx16 s[64:79], s[82:83], 0 glc
    s_sub_u32 s63, s63, 1
    s_cbranch_scc1 L_ready_I
L_check_I:
    s_waitcnt lgkmcnt(0)
    s_cmp_lg_u64 s[64:65], s[80:81]
    s_cbranch_scc1 L_poll_I
    s_cmp_lg_u64 s[66:67], s[80:81]
    s_cbranch_scc1 L_poll_I
    s_cmp_lg_u64 s[68:69], s[80:81]
    s_cbranch_scc1 L_poll_I
    s_cmp_lg_u64 s[70:71], s[80:81]
    s_cbranch_scc1 L_poll_I
    s_cmp_lg_u64 s[72:73], s[80:81]
    s_cbranch_scc1 L_poll_I
    s_cmp_lg_u64 s[74:75], s[80:81]
    s_cbranch_scc1 L_poll_I
    s_cmp_lg_u64 s[76:77], s[80:81]
    s_cbranch_scc1 L_poll_I
L_ready_I:
    buffer_load_dwordx4 v[96:99], v14, s[36:39], s48 offen offset:0 sc1
    buffer_load_dwordx4 v[100:103], v14, s[36:39], s48 offen offset:1024 sc1
    buffer_load_dwordx4 v[104:107], v14, s[36:39], s49 offen offset:0 sc1
    buffer_load_dwordx4 v[108:111], v14, s[36:39], s49 offen offset:1024 sc1
    buffer_load_dwordx4 v[112:115], v14, s[36:39], s50 offen offset:0 sc1
    s_barrier
    buffer_load_dwordx4 v[116:119], v14, s[36:39], s50 offen offset:1024 sc1
    buffer_load_dwordx4 v[120:123], v14, s[36:39], s51 offen offset:0 sc1
    buffer_load_dwordx4 v[124:127], v14, s[36:39], s51 offen offset:1024 sc1
    buffer_load_dwordx4 v[128:131], v14, s[36:39], s52 offen offset:0 sc1
    buffer_load_dwordx4 v[132:135], v14, s[36:39], s52 offen offset:1024 sc1
    s_branch L_p2
L_path2:
    s_waitcnt vmcnt(8) lgkmcnt(0)
    s_barrier
    ds_read_b64_tr_b16 v[96:97], v198 offset:0
    ds_read_b64_tr_b16 v[98:99], v198 offset:1024
    ds_read_b128 v[112:115], v192 offset:16384
    ds_read_b128 v[116:119], v192 offset:18432
    ds_read_b128 v[120:123], v192 offset:20480
    ds_read_b128 v[124:127], v192 offset:22528
    ds_read_b64_tr_b16 v[100:101], v199 offset:0
    ds_read_b64_tr_b16 v[102:103], v199 offset:1024
    ds_read_b64_tr_b16 v[104:105], v200 offset:0
    ds_read_b64_tr_b16 v[106:107], v200 offset:1024
    s_add_u32 m0, s47, 65536
    s_nop 0
    buffer_load_dwordx4 v6, s[20:23], s74 offen offset:0 lds
    s_waitcnt lgkmcnt(4)
    v_mfma_f32_16x16x32_bf16 v[32:35], v[96:99], v[112:115], 0
    ds_read_b64_tr_b16 v[108:109], v201 offset:0
    v_mfma_f32_16x16x32_bf16 v[36:39], v[96:99], v[116:119], 0
    ds_read_b64_tr_b16 v[110:111], v201 offset:1024
    v_mfma_f32_16x16x32_bf16 v[40:43], v[96:99], v[120:123], 0
    ds_read_b64_tr_b16 v[128:129], v198 offset:8192
    buffer_load_dwordx4 v7, s[20:23], s74 offen offset:1024 lds
    v_mfma_f32_16x16x32_bf16 v[44:47], v[96:99], v[124:127], 0
    ds_read_b64_tr_b16 v[130:131], v198 offset:9216
    s_waitcnt lgkmcnt(6)
    v_mfma_f32_16x16x32_bf16 v[60:63], v[100:103], v[124:127], 0
    ds_read_b128 v[144:147], v193 offset:16384
    v_mfma_f32_16x16x32_bf16 v[56:59], v[100:103], v[120:123], 0
    ds_read_b128 v[148:151], v193 offset:18432
    buffer_load_dwordx4 v8, s[20:23], s74 offen offset:2048 lds
    v_mfma_f32_16x16x32_bf16 v[52:55], v[100:103], v[116:119], 0
    ds_read_b128 v[152:155], v193 offset:20480
    v_mfma_f32_16x16x32_bf16 v[48:51], v[100:103], v[112:115], 0
    ds_read_b128 v[156:159], v193 offset:22528
    s_waitcnt lgkmcnt(8)
    v_mfma_f32_16x16x32_bf16 v[64:67], v[104:107], v[112:115], 0
    ds_read_b64_tr_b16 v[132:133], v199 offset:8192
    buffer_load_dwordx4 v9, s[20:23], s74 offen offset:3072 lds
    v_mfma_f32_16x16x32_bf16 v[68:71], v[104:107], v[116:119], 0
    ds_read_b64_tr_b16 v[134:135], v199 offset:9216
    v_mfma_f32_16x16x32_bf16 v[72:75], v[104:107], v[120:123], 0
    ds_read_b64_tr_b16 v[136:137], v200 offset:8192
    v_mfma_f32_16x16x32_bf16 v[76:79], v[104:107], v[124:127], 0
    ds_read_b64_tr_b16 v[138:139], v200 offset:9216
    s_waitcnt lgkmcnt(10)
    v_mfma_f32_16x16x32_bf16 v[92:95], v[108:111], v[124:127], 0
    ds_read_b64_tr_b16 v[140:141], v201 offset:8192
    v_mfma_f32_16x16x32_bf16 v[88:91], v[108:111], v[120:123], 0
    ds_read_b64_tr_b16 v[142:143], v201 offset:9216
    s_add_u32 m0, s47, 81920
    v_mfma_f32_16x16x32_bf16 v[84:87], v[108:111], v[116:119], 0
    buffer_load_dwordx4 v2, s[16:19], s66 offen offset:0 lds
    v_mfma_f32_16x16x32_bf16 v[80:83], v[108:111], v[112:115], 0
    s_waitcnt lgkmcnt(6)
    v_mfma_f32_16x16x32_bf16 v[32:35], v[128:131], v[144:147], v[32:35]
    buffer_load_dwordx4 v3, s[16:19], s66 offen offset:1024 lds
    v_mfma_f32_16x16x32_bf16 v[36:39], v[128:131], v[148:151], v[36:39]
    v_mfma_f32_16x16x32_bf16 v[40:43], v[128:131], v[152:155], v[40:43]
    buffer_load_dwordx4 v4, s[16:19], s66 offen offset:2048 lds
    v_mfma_f32_16x16x32_bf16 v[44:47], v[128:131], v[156:159], v[44:47]
    s_waitcnt lgkmcnt(4)
    v_mfma_f32_16x16x32_bf16 v[60:63], v[132:135], v[156:159], v[60:63]
    buffer_load_dwordx4 v5, s[16:19], s66 offen offset:3072 lds
    v_mfma_f32_16x16x32_bf16 v[56:59], v[132:135], v[152:155], v[56:59]
    v_mfma_f32_16x16x32_bf16 v[52:55], v[132:135], v[148:151], v[52:55]
    v_mfma_f32_16x16x32_bf16 v[48:51], v[132:135], v[144:147], v[48:51]
    s_waitcnt vmcnt(8) lgkmcnt(0)
    s_barrier
    v_mfma_f32_16x16x32_bf16 v[64:67], v[136:139], v[144:147], v[64:67]
    ds_read_b64_tr_b16 v[96:97], v198 offset:32768
    ds_read_b64_tr_b16 v[98:99], v198 offset:33792
    v_mfma_f32_16x16x32_bf16 v[68:71], v[136:139], v[148:151], v[68:71]
    ds_read_b128 v[112:115], v192 offset:49152
    ds_read_b128 v[116:119], v192 offset:51200
    v_mfma_f32_16x16x32_bf16 v[72:75], v[136:139], v[152:155], v[72:75]
    ds_read_b128 v[120:123], v192 offset:53248
    ds_read_b128 v[124:127], v192 offset:55296
    v_mfma_f32_16x16x32_bf16 v[76:79], v[136:139], v[156:159], v[76:79]
    ds_read_b64_tr_b16 v[100:101], v199 offset:32768
    v_mfma_f32_16x16x32_bf16 v[92:95], v[140:143], v[156:159], v[92:95]
    ds_read_b64_tr_b16 v[102:103], v199 offset:33792
    v_mfma_f32_16x16x32_bf16 v[88:91], v[140:143], v[152:155], v[88:91]
    ds_read_b64_tr_b16 v[104:105], v200 offset:32768
    v_mfma_f32_16x16x32_bf16 v[84:87], v[140:143], v[148:151], v[84:87]
    ds_read_b64_tr_b16 v[106:107], v200 offset:33792
    s_add_u32 m0, s47, 98304
    v_mfma_f32_16x16x32_bf16 v[80:83], v[140:143], v[144:147], v[80:83]
    buffer_load_dwordx4 v6, s[20:23], s75 offen offset:0 lds
    s_waitcnt lgkmcnt(4)
    v_mfma_f32_16x16x32_bf16 v[32:35], v[96:99], v[112:115], v[32:35]
    ds_read_b64_tr_b16 v[108:109], v201 offset:32768
    v_mfma_f32_16x16x32_bf16 v[36:39], v[96:99], v[116:119], v[36:39]
    ds_read_b64_tr_b16 v[110:111], v201 offset:33792
    v_mfma_f32_16x16x32_bf16 v[40:43], v[96:99], v[120:123], v[40:43]
    ds_read_b64_tr_b16 v[128:129], v198 offset:40960
    buffer_load_dwordx4 v7, s[20:23], s75 offen offset:1024 lds
    v_mfma_f32_16x16x32_bf16 v[44:47], v[96:99], v[124:127], v[44:47]
    ds_read_b64_tr_b16 v[130:131], v198 offset:41984
    s_waitcnt lgkmcnt(6)
    v_mfma_f32_16x16x32_bf16 v[60:63], v[100:103], v[124:127], v[60:63]
    ds_read_b128 v[144:147], v193 offset:49152
    v_mfma_f32_16x16x32_bf16 v[56:59], v[100:103], v[120:123], v[56:59]
    ds_read_b128 v[148:151], v193 offset:51200
    buffer_load_dwordx4 v8, s[20:23], s75 offen offset:2048 lds
    v_mfma_f32_16x16x32_bf16 v[52:55], v[100:103], v[116:119], v[52:55]
    ds_read_b128 v[152:155], v193 offset:53248
    v_mfma_f32_16x16x32_bf16 v[48:51], v[100:103], v[112:115], v[48:51]
    ds_read_b128 v[156:159], v193 offset:55296
    s_waitcnt lgkmcnt(8)
    v_mfma_f32_16x16x32_bf16 v[64:67], v[104:107], v[112:115], v[64:67]
    ds_read_b64_tr_b16 v[132:133], v199 offset:40960
    buffer_load_dwordx4 v9, s[20:23], s75 offen offset:3072 lds
    v_mfma_f32_16x16x32_bf16 v[68:71], v[104:107], v[116:119], v[68:71]
    ds_read_b64_tr_b16 v[134:135], v199 offset:41984
    v_mfma_f32_16x16x32_bf16 v[72:75], v[104:107], v[120:123], v[72:75]
    ds_read_b64_tr_b16 v[136:137], v200 offset:40960
    v_mfma_f32_16x16x32_bf16 v[76:79], v[104:107], v[124:127], v[76:79]
    ds_read_b64_tr_b16 v[138:139], v200 offset:41984
    s_waitcnt lgkmcnt(10)
    v_mfma_f32_16x16x32_bf16 v[92:95], v[108:111], v[124:127], v[92:95]
    ds_read_b64_tr_b16 v[140:141], v201 offset:40960
    v_mfma_f32_16x16x32_bf16 v[88:91], v[108:111], v[120:123], v[88:91]
    ds_read_b64_tr_b16 v[142:143], v201 offset:41984
    s_add_u32 m0, s47, 114688
    v_mfma_f32_16x16x32_bf16 v[84:87], v[108:111], v[116:119], v[84:87]
    buffer_load_dwordx4 v2, s[16:19], s67 offen offset:0 lds
    v_mfma_f32_16x16x32_bf16 v[80:83], v[108:111], v[112:115], v[80:83]
    s_waitcnt lgkmcnt(6)
    v_mfma_f32_16x16x32_bf16 v[32:35], v[128:131], v[144:147], v[32:35]
    buffer_load_dwordx4 v3, s[16:19], s67 offen offset:1024 lds
    v_mfma_f32_16x16x32_bf16 v[36:39], v[128:131], v[148:151], v[36:39]
    v_mfma_f32_16x16x32_bf16 v[40:43], v[128:131], v[152:155], v[40:43]
    buffer_load_dwordx4 v4, s[16:19], s67 offen offset:2048 lds
    v_mfma_f32_16x16x32_bf16 v[44:47], v[128:131], v[156:159], v[44:47]
    s_waitcnt lgkmcnt(4)
    v_mfma_f32_16x16x32_bf16 v[60:63], v[132:135], v[156:159], v[60:63]
    buffer_load_dwordx4 v5, s[16:19], s67 offen offset:3072 lds
    v_mfma_f32_16x16x32_bf16 v[56:59], v[132:135], v[152:155], v[56:59]
    v_mfma_f32_16x16x32_bf16 v[52:55], v[132:135], v[148:151], v[52:55]
    v_mfma_f32_16x16x32_bf16 v[48:51], v[132:135], v[144:147], v[48:51]
    s_waitcnt vmcnt(8) lgkmcnt(0)
    s_barrier
    v_mfma_f32_16x16x32_bf16 v[64:67], v[136:139], v[144:147], v[64:67]
    ds_read_b64_tr_b16 v[96:97], v202 offset:0
    ds_read_b64_tr_b16 v[98:99], v202 offset:1024
    v_mfma_f32_16x16x32_bf16 v[68:71], v[136:139], v[148:151], v[68:71]
    ds_read_b128 v[112:115], v194 offset:16384
    ds_read_b128 v[116:119], v194 offset:18432
    v_mfma_f32_16x16x32_bf16 v[72:75], v[136:139], v[152:155], v[72:75]
    ds_read_b128 v[120:123], v194 offset:20480
    ds_read_b128 v[124:127], v194 offset:22528
    v_mfma_f32_16x16x32_bf16 v[76:79], v[136:139], v[156:159], v[76:79]
    ds_read_b64_tr_b16 v[100:101], v203 offset:0
    v_mfma_f32_16x16x32_bf16 v[92:95], v[140:143], v[156:159], v[92:95]
    ds_read_b64_tr_b16 v[102:103], v203 offset:1024
    v_mfma_f32_16x16x32_bf16 v[88:91], v[140:143], v[152:155], v[88:91]
    ds_read_b64_tr_b16 v[104:105], v204 offset:0
    v_mfma_f32_16x16x32_bf16 v[84:87], v[140:143], v[148:151], v[84:87]
    ds_read_b64_tr_b16 v[106:107], v204 offset:1024
    s_add_u32 m0, s47, 131072
    v_mfma_f32_16x16x32_bf16 v[80:83], v[140:143], v[144:147], v[80:83]
    buffer_load_dwordx4 v6, s[20:23], s76 offen offset:0 lds
    s_waitcnt lgkmcnt(4)
    v_mfma_f32_16x16x32_bf16 v[32:35], v[96:99], v[112:115], v[32:35]
    ds_read_b64_tr_b16 v[108:109], v205 offset:0
    v_mfma_f32_16x16x32_bf16 v[36:39], v[96:99], v[116:119], v[36:39]
    ds_read_b64_tr_b16 v[110:111], v205 offset:1024
    v_mfma_f32_16x16x32_bf16 v[40:43], v[96:99], v[120:123], v[40:43]
    ds_read_b64_tr_b16 v[128:129], v202 offset:8192
    buffer_load_dwordx4 v7, s[20:23], s76 offen offset:1024 lds
    v_mfma_f32_16x16x32_bf16 v[44:47], v[96:99], v[124:127], v[44:47]
    ds_read_b64_tr_b16 v[130:131], v202 offset:9216
    s_waitcnt lgkmcnt(6)
    v_mfma_f32_16x16x32_bf16 v[60:63], v[100:103], v[124:127], v[60:63]
    ds_read_b128 v[144:147], v195 offset:16384
    v_mfma_f32_16x16x32_bf16 v[56:59], v[100:103], v[120:123], v[56:59]
    ds_read_b128 v[148:151], v195 offset:18432
    buffer_load_dwordx4 v8, s[20:23], s76 offen offset:2048 lds
    v_mfma_f32_16x16x32_bf16 v[52:55], v[100:103], v[116:119], v[52:55]
    ds_read_b128 v[152:155], v195 offset:20480
    v_mfma_f32_16x16x32_bf16 v[48:51], v[100:103], v[112:115], v[48:51]
    ds_read_b128 v[156:159], v195 offset:22528
    s_waitcnt lgkmcnt(8)
    v_mfma_f32_16x16x32_bf16 v[64:67], v[104:107], v[112:115], v[64:67]
    ds_read_b64_tr_b16 v[132:133], v203 offset:8192
    buffer_load_dwordx4 v9, s[20:23], s76 offen offset:3072 lds
    v_mfma_f32_16x16x32_bf16 v[68:71], v[104:107], v[116:119], v[68:71]
    ds_read_b64_tr_b16 v[134:135], v203 offset:9216
    v_mfma_f32_16x16x32_bf16 v[72:75], v[104:107], v[120:123], v[72:75]
    ds_read_b64_tr_b16 v[136:137], v204 offset:8192
    v_mfma_f32_16x16x32_bf16 v[76:79], v[104:107], v[124:127], v[76:79]
    ds_read_b64_tr_b16 v[138:139], v204 offset:9216
    s_waitcnt lgkmcnt(10)
    v_mfma_f32_16x16x32_bf16 v[92:95], v[108:111], v[124:127], v[92:95]
    ds_read_b64_tr_b16 v[140:141], v205 offset:8192
    v_mfma_f32_16x16x32_bf16 v[88:91], v[108:111], v[120:123], v[88:91]
    ds_read_b64_tr_b16 v[142:143], v205 offset:9216
    s_add_u32 m0, s47, 147456
    v_mfma_f32_16x16x32_bf16 v[84:87], v[108:111], v[116:119], v[84:87]
    buffer_load_dwordx4 v2, s[16:19], s68 offen offset:0 lds
    v_mfma_f32_16x16x32_bf16 v[80:83], v[108:111], v[112:115], v[80:83]
    s_waitcnt lgkmcnt(6)
    v_mfma_f32_16x16x32_bf16 v[32:35], v[128:131], v[144:147], v[32:35]
    buffer_load_dwordx4 v3, s[16:19], s68 offen offset:1024 lds
    v_mfma_f32_16x16x32_bf16 v[36:39], v[128:131], v[148:151], v[36:39]
    v_mfma_f32_16x16x32_bf16 v[40:43], v[128:131], v[152:155], v[40:43]
    buffer_load_dwordx4 v4, s[16:19], s68 offen offset:2048 lds
    v_mfma_f32_16x16x32_bf16 v[44:47], v[128:131], v[156:159], v[44:47]
    s_waitcnt lgkmcnt(4)
    v_mfma_f32_16x16x32_bf16 v[60:63], v[132:135], v[156:159], v[60:63]
    buffer_load_dwordx4 v5, s[16:19], s68 offen offset:3072 lds
    v_mfma_f32_16x16x32_bf16 v[56:59], v[132:135], v[152:155], v[56:59]
    v_mfma_f32_16x16x32_bf16 v[52:55], v[132:135], v[148:151], v[52:55]
    v_mfma_f32_16x16x32_bf16 v[48:51], v[132:135], v[144:147], v[48:51]
    buffer_load_dwordx2 v[20:21], v18, s[32:35], 0 offen sc1
    s_waitcnt vmcnt(9) lgkmcnt(0)
    s_barrier
    v_mfma_f32_16x16x32_bf16 v[64:67], v[136:139], v[144:147], v[64:67]
    ds_read_b64_tr_b16 v[96:97], v202 offset:32768
    ds_read_b64_tr_b16 v[98:99], v202 offset:33792
    v_mfma_f32_16x16x32_bf16 v[68:71], v[136:139], v[148:151], v[68:71]
    ds_read_b128 v[112:115], v194 offset:49152
    ds_read_b128 v[116:119], v194 offset:51200
    v_mfma_f32_16x16x32_bf16 v[72:75], v[136:139], v[152:155], v[72:75]
    ds_read_b128 v[120:123], v194 offset:53248
    ds_read_b128 v[124:127], v194 offset:55296
    v_mfma_f32_16x16x32_bf16 v[76:79], v[136:139], v[156:159], v[76:79]
    ds_read_b64_tr_b16 v[100:101], v203 offset:32768
    v_mfma_f32_16x16x32_bf16 v[92:95], v[140:143], v[156:159], v[92:95]
    ds_read_b64_tr_b16 v[102:103], v203 offset:33792
    v_mfma_f32_16x16x32_bf16 v[88:91], v[140:143], v[152:155], v[88:91]
    ds_read_b64_tr_b16 v[104:105], v204 offset:32768
    v_mfma_f32_16x16x32_bf16 v[84:87], v[140:143], v[148:151], v[84:87]
    ds_read_b64_tr_b16 v[106:107], v204 offset:33792
    s_add_u32 m0, s47, 0
    v_mfma_f32_16x16x32_bf16 v[80:83], v[140:143], v[144:147], v[80:83]
    buffer_load_dwordx4 v6, s[20:23], s77 offen offset:0 lds
    s_waitcnt lgkmcnt(4)
    v_mfma_f32_16x16x32_bf16 v[32:35], v[96:99], v[112:115], v[32:35]
    ds_read_b64_tr_b16 v[108:109], v205 offset:32768
    v_mfma_f32_16x16x32_bf16 v[36:39], v[96:99], v[116:119], v[36:39]
    ds_read_b64_tr_b16 v[110:111], v205 offset:33792
    v_mfma_f32_16x16x32_bf16 v[40:43], v[96:99], v[120:123], v[40:43]
    ds_read_b64_tr_b16 v[128:129], v202 offset:40960
    buffer_load_dwordx4 v7, s[20:23], s77 offen offset:1024 lds
    v_mfma_f32_16x16x32_bf16 v[44:47], v[96:99], v[124:127], v[44:47]
    ds_read_b64_tr_b16 v[130:131], v202 offset:41984
    s_waitcnt lgkmcnt(6)
    v_mfma_f32_16x16x32_bf16 v[60:63], v[100:103], v[124:127], v[60:63]
    ds_read_b128 v[144:147], v195 offset:49152
    v_mfma_f32_16x16x32_bf16 v[56:59], v[100:103], v[120:123], v[56:59]
    ds_read_b128 v[148:151], v195 offset:51200
    buffer_load_dwordx4 v8, s[20:23], s77 offen offset:2048 lds
    v_mfma_f32_16x16x32_bf16 v[52:55], v[100:103], v[116:119], v[52:55]
    ds_read_b128 v[152:155], v195 offset:53248
    v_mfma_f32_16x16x32_bf16 v[48:51], v[100:103], v[112:115], v[48:51]
    ds_read_b128 v[156:159], v195 offset:55296
    s_waitcnt lgkmcnt(8)
    v_mfma_f32_16x16x32_bf16 v[64:67], v[104:107], v[112:115], v[64:67]
    ds_read_b64_tr_b16 v[132:133], v203 offset:40960
    buffer_load_dwordx4 v9, s[20:23], s77 offen offset:3072 lds
    v_mfma_f32_16x16x32_bf16 v[68:71], v[104:107], v[116:119], v[68:71]
    ds_read_b64_tr_b16 v[134:135], v203 offset:41984
    v_mfma_f32_16x16x32_bf16 v[72:75], v[104:107], v[120:123], v[72:75]
    ds_read_b64_tr_b16 v[136:137], v204 offset:40960
    v_mfma_f32_16x16x32_bf16 v[76:79], v[104:107], v[124:127], v[76:79]
    ds_read_b64_tr_b16 v[138:139], v204 offset:41984
    s_waitcnt lgkmcnt(10)
    v_mfma_f32_16x16x32_bf16 v[92:95], v[108:111], v[124:127], v[92:95]
    ds_read_b64_tr_b16 v[140:141], v205 offset:40960
    v_mfma_f32_16x16x32_bf16 v[88:91], v[108:111], v[120:123], v[88:91]
    ds_read_b64_tr_b16 v[142:143], v205 offset:41984
    s_add_u32 m0, s47, 16384
    v_mfma_f32_16x16x32_bf16 v[84:87], v[108:111], v[116:119], v[84:87]
    buffer_load_dwordx4 v2, s[16:19], s69 offen offset:0 lds
    v_mfma_f32_16x16x32_bf16 v[80:83], v[108:111], v[112:115], v[80:83]
    s_waitcnt lgkmcnt(6)
    v_mfma_f32_16x16x32_bf16 v[32:35], v[128:131], v[144:147], v[32:35]
    buffer_load_dwordx4 v3, s[16:19], s69 offen offset:1024 lds
    v_mfma_f32_16x16x32_bf16 v[36:39], v[128:131], v[148:151], v[36:39]
    v_mfma_f32_16x16x32_bf16 v[40:43], v[128:131], v[152:155], v[40:43]
    buffer_load_dwordx4 v4, s[16:19], s69 offen offset:2048 lds
    v_mfma_f32_16x16x32_bf16 v[44:47], v[128:131], v[156:159], v[44:47]
    s_waitcnt lgkmcnt(4)
    v_mfma_f32_16x16x32_bf16 v[60:63], v[132:135], v[156:159], v[60:63]
    buffer_load_dwordx4 v5, s[16:19], s69 offen offset:3072 lds
    v_mfma_f32_16x16x32_bf16 v[56:59], v[132:135], v[152:155], v[56:59]
    v_mfma_f32_16x16x32_bf16 v[52:55], v[132:135], v[148:151], v[52:55]
    v_mfma_f32_16x16x32_bf16 v[48:51], v[132:135], v[144:147], v[48:51]
    s_waitcnt vmcnt(8) lgkmcnt(0)
    s_barrier
    v_mfma_f32_16x16x32_bf16 v[64:67], v[136:139], v[144:147], v[64:67]
    ds_read_b64_tr_b16 v[96:97], v206 offset:0
    ds_read_b64_tr_b16 v[98:99], v206 offset:1024
    v_mfma_f32_16x16x32_bf16 v[68:71], v[136:139], v[148:151], v[68:71]
    ds_read_b128 v[112:115], v196 offset:16384
    ds_read_b128 v[116:119], v196 offset:18432
    v_mfma_f32_16x16x32_bf16 v[72:75], v[136:139], v[152:155], v[72:75]
    ds_read_b128 v[120:123], v196 offset:20480
    ds_read_b128 v[124:127], v196 offset:22528
    v_mfma_f32_16x16x32_bf16 v[76:79], v[136:139], v[156:159], v[76:79]
    ds_read_b64_tr_b16 v[100:101], v207 offset:0
    v_mfma_f32_16x16x32_bf16 v[92:95], v[140:143], v[156:159], v[92:95]
    ds_read_b64_tr_b16 v[102:103], v207 offset:1024
    v_mfma_f32_16x16x32_bf16 v[88:91], v[140:143], v[152:155], v[88:91]
    ds_read_b64_tr_b16 v[104:105], v208 offset:0
    v_mfma_f32_16x16x32_bf16 v[84:87], v[140:143], v[148:151], v[84:87]
    ds_read_b64_tr_b16 v[106:107], v208 offset:1024
    s_add_u32 m0, s55, 32768
    v_mfma_f32_16x16x32_bf16 v[80:83], v[140:143], v[144:147], v[80:83]
    buffer_load_dwordx4 v10, s[24:27], s56 offen offset:0 lds
    s_waitcnt lgkmcnt(4)
    v_mfma_f32_16x16x32_bf16 v[32:35], v[96:99], v[112:115], v[32:35]
    ds_read_b64_tr_b16 v[108:109], v209 offset:0
    v_mfma_f32_16x16x32_bf16 v[36:39], v[96:99], v[116:119], v[36:39]
    ds_read_b64_tr_b16 v[110:111], v209 offset:1024
    v_mfma_f32_16x16x32_bf16 v[40:43], v[96:99], v[120:123], v[40:43]
    ds_read_b64_tr_b16 v[128:129], v206 offset:8192
    buffer_load_dwordx4 v11, s[24:27], s56 offen offset:1024 lds
    v_mfma_f32_16x16x32_bf16 v[44:47], v[96:99], v[124:127], v[44:47]
    ds_read_b64_tr_b16 v[130:131], v206 offset:9216
    s_waitcnt lgkmcnt(6)
    v_mfma_f32_16x16x32_bf16 v[60:63], v[100:103], v[124:127], v[60:63]
    ds_read_b128 v[144:147], v197 offset:16384
    v_mfma_f32_16x16x32_bf16 v[56:59], v[100:103], v[120:123], v[56:59]
    ds_read_b128 v[148:151], v197 offset:18432
    buffer_load_dwordx4 v12, s[24:27], s56 offen offset:2048 lds
    v_mfma_f32_16x16x32_bf16 v[52:55], v[100:103], v[116:119], v[52:55]
    ds_read_b128 v[152:155], v197 offset:20480
    v_mfma_f32_16x16x32_bf16 v[48:51], v[100:103], v[112:115], v[48:51]
    ds_read_b128 v[156:159], v197 offset:22528
    s_waitcnt lgkmcnt(8)
    v_mfma_f32_16x16x32_bf16 v[64:67], v[104:107], v[112:115], v[64:67]
    ds_read_b64_tr_b16 v[132:133], v207 offset:8192
    buffer_load_dwordx4 v13, s[24:27], s56 offen offset:3072 lds
    v_mfma_f32_16x16x32_bf16 v[68:71], v[104:107], v[116:119], v[68:71]
    ds_read_b64_tr_b16 v[134:135], v207 offset:9216
    v_mfma_f32_16x16x32_bf16 v[72:75], v[104:107], v[120:123], v[72:75]
    ds_read_b64_tr_b16 v[136:137], v208 offset:8192
    v_mfma_f32_16x16x32_bf16 v[76:79], v[104:107], v[124:127], v[76:79]
    ds_read_b64_tr_b16 v[138:139], v208 offset:9216
    s_waitcnt lgkmcnt(10)
    v_mfma_f32_16x16x32_bf16 v[92:95], v[108:111], v[124:127], v[92:95]
    ds_read_b64_tr_b16 v[140:141], v209 offset:8192
    v_mfma_f32_16x16x32_bf16 v[88:91], v[108:111], v[120:123], v[88:91]
    ds_read_b64_tr_b16 v[142:143], v209 offset:9216
    s_add_u32 m0, s55, 36864
    s_add_u32 s46, s56, 32768
    v_mfma_f32_16x16x32_bf16 v[84:87], v[108:111], v[116:119], v[84:87]
    buffer_load_dwordx4 v10, s[24:27], s46 offen offset:0 lds
    v_mfma_f32_16x16x32_bf16 v[80:83], v[108:111], v[112:115], v[80:83]
    s_waitcnt lgkmcnt(6)
    v_mfma_f32_16x16x32_bf16 v[32:35], v[128:131], v[144:147], v[32:35]
    buffer_load_dwordx4 v11, s[24:27], s46 offen offset:1024 lds
    v_mfma_f32_16x16x32_bf16 v[36:39], v[128:131], v[148:151], v[36:39]
    v_mfma_f32_16x16x32_bf16 v[40:43], v[128:131], v[152:155], v[40:43]
    buffer_load_dwordx4 v12, s[24:27], s46 offen offset:2048 lds
    v_mfma_f32_16x16x32_bf16 v[44:47], v[128:131], v[156:159], v[44:47]
    s_waitcnt lgkmcnt(4)
    v_mfma_f32_16x16x32_bf16 v[60:63], v[132:135], v[156:159], v[60:63]
    buffer_load_dwordx4 v13, s[24:27], s46 offen offset:3072 lds
    v_mfma_f32_16x16x32_bf16 v[56:59], v[132:135], v[152:155], v[56:59]
    v_mfma_f32_16x16x32_bf16 v[52:55], v[132:135], v[148:151], v[52:55]
    v_mfma_f32_16x16x32_bf16 v[48:51], v[132:135], v[144:147], v[48:51]
    s_waitcnt vmcnt(8) lgkmcnt(0)
    s_barrier
    v_mfma_f32_16x16x32_bf16 v[64:67], v[136:139], v[144:147], v[64:67]
    ds_read_b64_tr_b16 v[96:97], v198 offset:0
    ds_read_b64_tr_b16 v[98:99], v198 offset:1024
    v_mfma_f32_16x16x32_bf16 v[68:71], v[136:139], v[148:151], v[68:71]
    ds_read_b128 v[112:115], v192 offset:16384
    ds_read_b128 v[116:119], v192 offset:18432
    v_mfma_f32_16x16x32_bf16 v[72:75], v[136:139], v[152:155], v[72:75]
    ds_read_b128 v[120:123], v192 offset:20480
    ds_read_b128 v[124:127], v192 offset:22528
    v_mfma_f32_16x16x32_bf16 v[76:79], v[136:139], v[156:159], v[76:79]
    ds_read_b64_tr_b16 v[100:101], v199 offset:0
    v_mfma_f32_16x16x32_bf16 v[92:95], v[140:143], v[156:159], v[92:95]
    ds_read_b64_tr_b16 v[102:103], v199 offset:1024
    v_mfma_f32_16x16x32_bf16 v[88:91], v[140:143], v[152:155], v[88:91]
    ds_read_b64_tr_b16 v[104:105], v200 offset:0
    v_mfma_f32_16x16x32_bf16 v[84:87], v[140:143], v[148:151], v[84:87]
    ds_read_b64_tr_b16 v[106:107], v200 offset:1024
    s_add_u32 m0, s47, 65536
    v_mfma_f32_16x16x32_bf16 v[80:83], v[140:143], v[144:147], v[80:83]
    buffer_load_dwordx4 v6, s[20:23], s78 offen offset:0 lds
    s_waitcnt lgkmcnt(4)
    v_mfma_f32_16x16x32_bf16 v[32:35], v[96:99], v[112:115], v[32:35]
    ds_read_b64_tr_b16 v[108:109], v201 offset:0
    v_mfma_f32_16x16x32_bf16 v[36:39], v[96:99], v[116:119], v[36:39]
    ds_read_b64_tr_b16 v[110:111], v201 offset:1024
    v_mfma_f32_16x16x32_bf16 v[40:43], v[96:99], v[120:123], v[40:43]
    ds_read_b64_tr_b16 v[128:129], v198 offset:8192
    buffer_load_dwordx4 v7, s[20:23], s78 offen offset:1024 lds
    v_mfma_f32_16x16x32_bf16 v[44:47], v[96:99], v[124:127], v[44:47]
    ds_read_b64_tr_b16 v[130:131], v198 offset:9216
    s_waitcnt lgkmcnt(6)
    v_mfma_f32_16x16x32_bf16 v[60:63], v[100:103], v[124:127], v[60:63]
    ds_read_b128 v[144:147], v193 offset:16384
    v_mfma_f32_16x16x32_bf16 v[56:59], v[100:103], v[120:123], v[56:59]
    ds_read_b128 v[148:151], v193 offset:18432
    buffer_load_dwordx4 v8, s[20:23], s78 offen offset:2048 lds
    v_mfma_f32_16x16x32_bf16 v[52:55], v[100:103], v[116:119], v[52:55]
    ds_read_b128 v[152:155], v193 offset:20480
    v_mfma_f32_16x16x32_bf16 v[48:51], v[100:103], v[112:115], v[48:51]
    ds_read_b128 v[156:159], v193 offset:22528
    s_waitcnt lgkmcnt(8)
    v_mfma_f32_16x16x32_bf16 v[64:67], v[104:107], v[112:115], v[64:67]
    ds_read_b64_tr_b16 v[132:133], v199 offset:8192
    buffer_load_dwordx4 v9, s[20:23], s78 offen offset:3072 lds
    v_mfma_f32_16x16x32_bf16 v[68:71], v[104:107], v[116:119], v[68:71]
    ds_read_b64_tr_b16 v[134:135], v199 offset:9216
    v_mfma_f32_16x16x32_bf16 v[72:75], v[104:107], v[120:123], v[72:75]
    ds_read_b64_tr_b16 v[136:137], v200 offset:8192
    v_mfma_f32_16x16x32_bf16 v[76:79], v[104:107], v[124:127], v[76:79]
    ds_read_b64_tr_b16 v[138:139], v200 offset:9216
    s_waitcnt lgkmcnt(10)
    v_mfma_f32_16x16x32_bf16 v[92:95], v[108:111], v[124:127], v[92:95]
    ds_read_b64_tr_b16 v[140:141], v201 offset:8192
    v_mfma_f32_16x16x32_bf16 v[88:91], v[108:111], v[120:123], v[88:91]
    ds_read_b64_tr_b16 v[142:143], v201 offset:9216
    s_add_u32 m0, s47, 81920
    v_mfma_f32_16x16x32_bf16 v[84:87], v[108:111], v[116:119], v[84:87]
    buffer_load_dwordx4 v2, s[16:19], s70 offen offset:0 lds
    v_mfma_f32_16x16x32_bf16 v[80:83], v[108:111], v[112:115], v[80:83]
    s_waitcnt lgkmcnt(6)
    v_mfma_f32_16x16x32_bf16 v[32:35], v[128:131], v[144:147], v[32:35]
    buffer_load_dwordx4 v3, s[16:19], s70 offen offset:1024 lds
    v_mfma_f32_16x16x32_bf16 v[36:39], v[128:131], v[148:151], v[36:39]
    v_mfma_f32_16x16x32_bf16 v[40:43], v[128:131], v[152:155], v[40:43]
    buffer_load_dwordx4 v4, s[16:19], s70 offen offset:2048 lds
    v_mfma_f32_16x16x32_bf16 v[44:47], v[128:131], v[156:159], v[44:47]
    s_waitcnt lgkmcnt(4)
    v_mfma_f32_16x16x32_bf16 v[60:63], v[132:135], v[156:159], v[60:63]
    buffer_load_dwordx4 v5, s[16:19], s70 offen offset:3072 lds
    v_mfma_f32_16x16x32_bf16 v[56:59], v[132:135], v[152:155], v[56:59]
    v_mfma_f32_16x16x32_bf16 v[52:55], v[132:135], v[148:151], v[52:55]
    v_mfma_f32_16x16x32_bf16 v[48:51], v[132:135], v[144:147], v[48:51]
    s_waitcnt vmcnt(8) lgkmcnt(0)
    s_barrier
    v_mfma_f32_16x16x32_bf16 v[64:67], v[136:139], v[144:147], v[64:67]
    ds_read_b64_tr_b16 a[0:1], v210 offset:32768
    ds_read_b64_tr_b16 a[2:3], v210 offset:34816
    v_mfma_f32_16x16x32_bf16 v[68:71], v[136:139], v[148:151], v[68:71]
    ds_read_b64_tr_b16 a[4:5], v211 offset:32768
    ds_read_b64_tr_b16 a[6:7], v211 offset:34816
    v_mfma_f32_16x16x32_bf16 v[72:75], v[136:139], v[152:155], v[72:75]
    ds_read_b64_tr_b16 a[8:9], v212 offset:32768
    ds_read_b64_tr_b16 a[10:11], v212 offset:34816
    v_mfma_f32_16x16x32_bf16 v[76:79], v[136:139], v[156:159], v[76:79]
    ds_read_b64_tr_b16 a[12:13], v213 offset:32768
    ds_read_b64_tr_b16 a[14:15], v213 offset:34816
    v_mfma_f32_16x16x32_bf16 v[92:95], v[140:143], v[156:159], v[92:95]
    ds_read_b64_tr_b16 a[16:17], v210 offset:36864
    ds_read_b64_tr_b16 a[18:19], v210 offset:38912
    v_mfma_f32_16x16x32_bf16 v[88:91], v[140:143], v[152:155], v[88:91]
    ds_read_b64_tr_b16 a[20:21], v211 offset:36864
    ds_read_b64_tr_b16 a[22:23], v211 offset:38912
    v_mfma_f32_16x16x32_bf16 v[84:87], v[140:143], v[148:151], v[84:87]
    v_mfma_f32_16x16x32_bf16 v[80:83], v[140:143], v[144:147], v[80:83]
    s_waitcnt lgkmcnt(4)
    ds_read_b64_tr_b16 a[24:25], v212 offset:36864
    ds_read_b64_tr_b16 a[26:27], v212 offset:38912
    ds_read_b64_tr_b16 a[28:29], v213 offset:36864
    ds_read_b64_tr_b16 a[30:31], v213 offset:38912
    s_add_u32 m0, s47, 98304
    s_nop 0
    buffer_load_dwordx4 v6, s[20:23], s79 offen offset:0 lds
    buffer_load_dwordx4 v7, s[20:23], s79 offen offset:1024 lds
    buffer_load_dwordx4 v8, s[20:23], s79 offen offset:2048 lds
    buffer_load_dwordx4 v9, s[20:23], s79 offen offset:3072 lds
    s_add_u32 m0, s47, 114688
    s_nop 0
    buffer_load_dwordx4 v2, s[16:19], s71 offen offset:0 lds
    buffer_load_dwordx4 v3, s[16:19], s71 offen offset:1024 lds
    buffer_load_dwordx4 v4, s[16:19], s71 offen offset:2048 lds
    buffer_load_dwordx4 v5, s[16:19], s71 offen offset:3072 lds
    s_waitcnt vmcnt(8) lgkmcnt(0)
    s_barrier
    ds_read_b64_tr_b16 v[96:97], v202 offset:0
    ds_read_b64_tr_b16 v[98:99], v202 offset:1024
    ds_read_b128 v[112:115], v194 offset:16384
    ds_read_b128 v[116:119], v194 offset:18432
    ds_read_b128 v[120:123], v194 offset:20480
    ds_read_b128 v[124:127], v194 offset:22528
    ds_read_b64_tr_b16 v[100:101], v203 offset:0
    ds_read_b64_tr_b16 v[102:103], v203 offset:1024
    ds_read_b64_tr_b16 v[104:105], v204 offset:0
    ds_read_b64_tr_b16 v[106:107], v204 offset:1024
    s_add_u32 m0, s55, 131072
    s_nop 0
    buffer_load_dwordx4 v10, s[24:27], s61 offen offset:0 lds
    s_waitcnt lgkmcnt(4)
    v_mfma_f32_16x16x32_bf16 v[32:35], v[96:99], v[112:115], v[32:35]
    ds_read_b64_tr_b16 v[108:109], v205 offset:0
    v_mfma_f32_16x16x32_bf16 v[36:39], v[96:99], v[116:119], v[36:39]
    ds_read_b64_tr_b16 v[110:111], v205 offset:1024
    v_mfma_f32_16x16x32_bf16 v[40:43], v[96:99], v[120:123], v[40:43]
    ds_read_b64_tr_b16 v[128:129], v202 offset:8192
    buffer_load_dwordx4 v11, s[24:27], s61 offen offset:1024 lds
    v_mfma_f32_16x16x32_bf16 v[44:47], v[96:99], v[124:127], v[44:47]
    ds_read_b64_tr_b16 v[130:131], v202 offset:9216
    s_waitcnt lgkmcnt(6)
    v_mfma_f32_16x16x32_bf16 v[60:63], v[100:103], v[124:127], v[60:63]
    ds_read_b128 v[144:147], v195 offset:16384
    v_mfma_f32_16x16x32_bf16 v[56:59], v[100:103], v[120:123], v[56:59]
    ds_read_b128 v[148:151], v195 offset:18432
    buffer_load_dwordx4 v12, s[24:27], s61 offen offset:2048 lds
    v_mfma_f32_16x16x32_bf16 v[52:55], v[100:103], v[116:119], v[52:55]
    ds_read_b128 v[152:155], v195 offset:20480
    v_mfma_f32_16x16x32_bf16 v[48:51], v[100:103], v[112:115], v[48:51]
    ds_read_b128 v[156:159], v195 offset:22528
    s_waitcnt lgkmcnt(8)
    v_mfma_f32_16x16x32_bf16 v[64:67], v[104:107], v[112:115], v[64:67]
    ds_read_b64_tr_b16 v[132:133], v203 offset:8192
    buffer_load_dwordx4 v13, s[24:27], s61 offen offset:3072 lds
    v_mfma_f32_16x16x32_bf16 v[68:71], v[104:107], v[116:119], v[68:71]
    ds_read_b64_tr_b16 v[134:135], v203 offset:9216
    v_mfma_f32_16x16x32_bf16 v[72:75], v[104:107], v[120:123], v[72:75]
    ds_read_b64_tr_b16 v[136:137], v204 offset:8192
    v_mfma_f32_16x16x32_bf16 v[76:79], v[104:107], v[124:127], v[76:79]
    ds_read_b64_tr_b16 v[138:139], v204 offset:9216
    s_waitcnt lgkmcnt(10)
    v_mfma_f32_16x16x32_bf16 v[92:95], v[108:111], v[124:127], v[92:95]
    ds_read_b64_tr_b16 v[140:141], v205 offset:8192
    v_mfma_f32_16x16x32_bf16 v[88:91], v[108:111], v[120:123], v[88:91]
    ds_read_b64_tr_b16 v[142:143], v205 offset:9216
    s_add_u32 m0, s55, 135168
    s_add_u32 s46, s61, 32768
    v_mfma_f32_16x16x32_bf16 v[84:87], v[108:111], v[116:119], v[84:87]
    buffer_load_dwordx4 v10, s[24:27], s46 offen offset:0 lds
    v_mfma_f32_16x16x32_bf16 v[80:83], v[108:111], v[112:115], v[80:83]
    s_waitcnt lgkmcnt(6)
    v_mfma_f32_16x16x32_bf16 v[32:35], v[128:131], v[144:147], v[32:35]
    buffer_load_dwordx4 v11, s[24:27], s46 offen offset:1024 lds
    v_mfma_f32_16x16x32_bf16 v[36:39], v[128:131], v[148:151], v[36:39]
    v_mfma_f32_16x16x32_bf16 v[40:43], v[128:131], v[152:155], v[40:43]
    buffer_load_dwordx4 v12, s[24:27], s46 offen offset:2048 lds
    v_mfma_f32_16x16x32_bf16 v[44:47], v[128:131], v[156:159], v[44:47]
    s_waitcnt lgkmcnt(4)
    v_mfma_f32_16x16x32_bf16 v[60:63], v[132:135], v[156:159], v[60:63]
    buffer_load_dwordx4 v13, s[24:27], s46 offen offset:3072 lds
    v_mfma_f32_16x16x32_bf16 v[56:59], v[132:135], v[152:155], v[56:59]
    v_mfma_f32_16x16x32_bf16 v[52:55], v[132:135], v[148:151], v[52:55]
    v_mfma_f32_16x16x32_bf16 v[48:51], v[132:135], v[144:147], v[48:51]
    s_waitcnt vmcnt(8) lgkmcnt(0)
    s_barrier
    v_mfma_f32_16x16x32_bf16 v[64:67], v[136:139], v[144:147], v[64:67]
    ds_read_b64_tr_b16 v[96:97], v202 offset:32768
    ds_read_b64_tr_b16 v[98:99], v202 offset:33792
    v_mfma_f32_16x16x32_bf16 v[68:71], v[136:139], v[148:151], v[68:71]
    ds_read_b128 v[112:115], v194 offset:49152
    ds_read_b128 v[116:119], v194 offset:51200
    v_mfma_f32_16x16x32_bf16 v[72:75], v[136:139], v[152:155], v[72:75]
    ds_read_b128 v[120:123], v194 offset:53248
    ds_read_b128 v[124:127], v194 offset:55296
    v_mfma_f32_16x16x32_bf16 v[76:79], v[136:139], v[156:159], v[76:79]
    ds_read_b64_tr_b16 v[100:101], v203 offset:32768
    v_mfma_f32_16x16x32_bf16 v[92:95], v[140:143], v[156:159], v[92:95]
    ds_read_b64_tr_b16 v[102:103], v203 offset:33792
    v_mfma_f32_16x16x32_bf16 v[88:91], v[140:143], v[152:155], v[88:91]
    ds_read_b64_tr_b16 v[104:105], v204 offset:32768
    s_add_u32 m0, s55, 0
    v_mfma_f32_16x16x32_bf16 v[84:87], v[140:143], v[148:151], v[84:87]
    ds_read_b64_tr_b16 v[106:107], v204 offset:33792
    buffer_load_dwordx4 v10, s[24:27], s62 offen offset:0 lds
    v_mfma_f32_16x16x32_bf16 v[80:83], v[140:143], v[144:147], v[80:83]
    s_waitcnt lgkmcnt(4)
    v_mfma_f32_16x16x32_bf16 v[32:35], v[96:99], v[112:115], v[32:35]
    ds_read_b64_tr_b16 v[108:109], v205 offset:32768
    v_mfma_f32_16x16x32_bf16 v[36:39], v[96:99], v[116:119], v[36:39]
    ds_read_b64_tr_b16 v[110:111], v205 offset:33792
    buffer_load_dwordx4 v11, s[24:27], s62 offen offset:1024 lds
    v_mfma_f32_16x16x32_bf16 v[40:43], v[96:99], v[120:123], v[40:43]
    ds_read_b64_tr_b16 v[128:129], v202 offset:40960
    v_mfma_f32_16x16x32_bf16 v[44:47], v[96:99], v[124:127], v[44:47]
    ds_read_b64_tr_b16 v[130:131], v202 offset:41984
    s_waitcnt lgkmcnt(6)
    v_mfma_f32_16x16x32_bf16 v[60:63], v[100:103], v[124:127], v[60:63]
    ds_read_b128 v[144:147], v195 offset:49152
    buffer_load_dwordx4 v12, s[24:27], s62 offen offset:2048 lds
    v_mfma_f32_16x16x32_bf16 v[56:59], v[100:103], v[120:123], v[56:59]
    ds_read_b128 v[148:151], v195 offset:51200
    v_mfma_f32_16x16x32_bf16 v[52:55], v[100:103], v[116:119], v[52:55]
    ds_read_b128 v[152:155], v195 offset:53248
    v_mfma_f32_16x16x32_bf16 v[48:51], v[100:103], v[112:115], v[48:51]
    ds_read_b128 v[156:159], v195 offset:55296
    buffer_load_dwordx4 v13, s[24:27], s62 offen offset:3072 lds
    s_waitcnt lgkmcnt(8)
    v_mfma_f32_16x16x32_bf16 v[64:67], v[104:107], v[112:115], v[64:67]
    ds_read_b64_tr_b16 v[132:133], v203 offset:40960
    s_add_u32 m0, s55, 4096
    s_add_u32 s46, s62, 32768
    v_mfma_f32_16x16x32_bf16 v[68:71], v[104:107], v[116:119], v[68:71]
    ds_read_b64_tr_b16 v[134:135], v203 offset:41984
    buffer_load_dwordx4 v10, s[24:27], s46 offen offset:0 lds
    v_mfma_f32_16x16x32_bf16 v[72:75], v[104:107], v[120:123], v[72:75]
    ds_read_b64_tr_b16 v[136:137], v204 offset:40960
    v_mfma_f32_16x16x32_bf16 v[76:79], v[104:107], v[124:127], v[76:79]
    ds_read_b64_tr_b16 v[138:139], v204 offset:41984
    buffer_load_dwordx4 v11, s[24:27], s46 offen offset:1024 lds
    s_waitcnt lgkmcnt(10)
    v_mfma_f32_16x16x32_bf16 v[92:95], v[108:111], v[124:127], v[92:95]
    ds_read_b64_tr_b16 v[140:141], v205 offset:40960
    v_mfma_f32_16x16x32_bf16 v[88:91], v[108:111], v[120:123], v[88:91]
    ds_read_b64_tr_b16 v[142:143], v205 offset:41984
    buffer_load_dwordx4 v12, s[24:27], s46 offen offset:2048 lds
    v_mfma_f32_16x16x32_bf16 v[84:87], v[108:111], v[116:119], v[84:87]
    v_mfma_f32_16x16x32_bf16 v[80:83], v[108:111], v[112:115], v[80:83]
    buffer_load_dwordx4 v13, s[24:27], s46 offen offset:3072 lds
    s_waitcnt lgkmcnt(4)
    v_mfma_f32_16x16x32_bf16 v[32:35], v[128:131], v[144:147], v[32:35]
    v_mfma_f32_16x16x32_bf16 v[36:39], v[128:131], v[148:151], v[36:39]
    v_mfma_f32_16x16x32_bf16 v[40:43], v[128:131], v[152:155], v[40:43]
    v_mfma_f32_16x16x32_bf16 v[44:47], v[128:131], v[156:159], v[44:47]
    v_readfirstlane_b32 s81, v21
    s_mov_b32 s63, 0x40000
L_non_V:
    s_cmp_lg_u32 s81, 0
    s_cbranch_scc1 L_nonok_V
    buffer_load_dwordx2 v[20:21], v18, s[32:35], 0 offen sc1
    s_waitcnt vmcnt(0)
    v_readfirstlane_b32 s81, v21
    s_sub_u32 s63, s63, 1
    s_cbranch_scc0 L_non_V
L_nonok_V:
    v_readfirstlane_b32 s80, v20
    s_mov_b32 s43, 57344
    s_mov_b32 s44, 114688
    s_mov_b32 s45, 172032
    v_mfma_f32_16x16x32_bf16 v[60:63], v[132:135], v[156:159], v[60:63]
    v_mfma_f32_16x16x32_bf16 v[56:59], v[132:135], v[152:155], v[56:59]
    v_mfma_f32_16x16x32_bf16 v[52:55], v[132:135], v[148:151], v[52:55]
    v_mfma_f32_16x16x32_bf16 v[48:51], v[132:135], v[144:147], v[48:51]
    s_waitcnt lgkmcnt(0)
    v_mfma_f32_16x16x32_bf16 v[64:67], v[136:139], v[144:147], v[64:67]
    v_mfma_f32_16x16x32_bf16 v[68:71], v[136:139], v[148:151], v[68:71]
    s_nop 2
    v_mfma_f32_16x16x32_bf16 v[72:75], v[136:139], v[152:155], v[72:75]
    v_cvt_pk_bf16_f32 v172, v44, v45
    v_cvt_pk_bf16_f32 v173, v46, v47
    v_cvt_pk_bf16_f32 v174, v60, v61
    v_mfma_f32_16x16x32_bf16 v[76:79], v[136:139], v[156:159], v[76:79]
    v_cvt_pk_bf16_f32 v175, v62, v63
    v_pk_max_i16 v172, v172, 0
    v_pk_max_i16 v173, v173, 0
    v_mfma_f32_16x16x32_bf16 v[92:95], v[140:143], v[156:159], v[92:95]
    v_pk_max_i16 v174, v174, 0
    v_pk_max_i16 v175, v175, 0
    buffer_store_dwordx4 v[172:175], v22, s[36:39], s45 offen offset:0 sc1
    v_mfma_f32_16x16x32_bf16 v[88:91], v[140:143], v[152:155], v[88:91]
    v_cvt_pk_bf16_f32 v168, v40, v41
    v_cvt_pk_bf16_f32 v169, v42, v43
    v_cvt_pk_bf16_f32 v170, v56, v57
    v_mfma_f32_16x16x32_bf16 v[84:87], v[140:143], v[148:151], v[84:87]
    v_cvt_pk_bf16_f32 v171, v58, v59
    v_pk_max_i16 v168, v168, 0
    v_pk_max_i16 v169, v169, 0
    v_mfma_f32_16x16x32_bf16 v[80:83], v[140:143], v[144:147], v[80:83]
    v_pk_max_i16 v170, v170, 0
    v_pk_max_i16 v171, v171, 0
    buffer_store_dwordx4 v[168:171], v22, s[36:39], s44 offen offset:0 sc1
    v_cvt_pk_bf16_f32 v164, v36, v37
    v_cvt_pk_bf16_f32 v165, v38, v39
    v_cvt_pk_bf16_f32 v166, v52, v53
    v_cvt_pk_bf16_f32 v167, v54, v55
    v_pk_max_i16 v164, v164, 0
    v_pk_max_i16 v165, v165, 0
    v_pk_max_i16 v166, v166, 0
    v_pk_max_i16 v167, v167, 0
    buffer_store_dwordx4 v[164:167], v22, s[36:39], s43 offen offset:0 sc1
    v_cvt_pk_bf16_f32 v160, v32, v33
    v_cvt_pk_bf16_f32 v161, v34, v35
    v_cvt_pk_bf16_f32 v162, v48, v49
    v_cvt_pk_bf16_f32 v163, v50, v51
    v_pk_max_i16 v160, v160, 0
    v_pk_max_i16 v161, v161, 0
    v_pk_max_i16 v162, v162, 0
    v_pk_max_i16 v163, v163, 0
    buffer_store_dwordx4 v[160:163], v22, s[36:39], 0 offen offset:0 sc1
    v_cvt_pk_bf16_f32 v188, v76, v77
    v_cvt_pk_bf16_f32 v189, v78, v79
    v_cvt_pk_bf16_f32 v190, v92, v93
    v_cvt_pk_bf16_f32 v191, v94, v95
    v_pk_max_i16 v188, v188, 0
    v_pk_max_i16 v189, v189, 0
    v_pk_max_i16 v190, v190, 0
    v_pk_max_i16 v191, v191, 0
    buffer_store_dwordx4 v[188:191], v22, s[36:39], s45 offen offset:1024 sc1
    v_cvt_pk_bf16_f32 v184, v72, v73
    v_cvt_pk_bf16_f32 v185, v74, v75
    v_cvt_pk_bf16_f32 v186, v88, v89
    v_cvt_pk_bf16_f32 v187, v90, v91
    v_pk_max_i16 v184, v184, 0
    v_pk_max_i16 v185, v185, 0
    v_pk_max_i16 v186, v186, 0
    v_pk_max_i16 v187, v187, 0
    buffer_store_dwordx4 v[184:187], v22, s[36:39], s44 offen offset:1024 sc1
    v_cvt_pk_bf16_f32 v180, v68, v69
    v_cvt_pk_bf16_f32 v181, v70, v71
    v_cvt_pk_bf16_f32 v182, v84, v85
    v_cvt_pk_bf16_f32 v183, v86, v87
    v_pk_max_i16 v180, v180, 0
    v_pk_max_i16 v181, v181, 0
    v_pk_max_i16 v182, v182, 0
    v_pk_max_i16 v183, v183, 0
    buffer_store_dwordx4 v[180:183], v22, s[36:39], s43 offen offset:1024 sc1
    v_cvt_pk_bf16_f32 v176, v64, v65
    v_cvt_pk_bf16_f32 v177, v66, v67
    v_cvt_pk_bf16_f32 v178, v80, v81
    v_cvt_pk_bf16_f32 v179, v82, v83
    v_pk_max_i16 v176, v176, 0
    v_pk_max_i16 v177, v177, 0
    v_pk_max_i16 v178, v178, 0
    v_pk_max_i16 v179, v179, 0
    buffer_store_dwordx4 v[176:179], v22, s[36:39], 0 offen offset:1024 sc1
    s_barrier
    s_add_u32 m0, s55, 32768
    s_nop 0
    buffer_load_dwordx4 v10, s[24:27], s57 offen offset:0 lds
    buffer_load_dwordx4 v11, s[24:27], s57 offen offset:1024 lds
    buffer_load_dwordx4 v12, s[24:27], s57 offen offset:2048 lds
    buffer_load_dwordx4 v13, s[24:27], s57 offen offset:3072 lds
    s_add_u32 m0, s55, 36864
    s_add_u32 s46, s57, 32768
    buffer_load_dwordx4 v10, s[24:27], s46 offen offset:0 lds
    buffer_load_dwordx4 v11, s[24:27], s46 offen offset:1024 lds
    buffer_load_dwordx4 v12, s[24:27], s46 offen offset:2048 lds
    buffer_load_dwordx4 v13, s[24:27], s46 offen offset:3072 lds
    s_waitcnt vmcnt(24) lgkmcnt(4)
    ds_read_b64_tr_b16 a[160:161], v218 offset:0
    ds_read_b64_tr_b16 a[162:163], v218 offset:2048
    ds_read_b64_tr_b16 a[164:165], v219 offset:0
    ds_read_b64_tr_b16 a[166:167], v219 offset:2048
    ds_read_b64_tr_b16 a[168:169], v220 offset:0
    ds_read_b64_tr_b16 a[170:171], v220 offset:2048
    ds_read_b64_tr_b16 a[172:173], v221 offset:0
    ds_read_b64_tr_b16 a[174:175], v221 offset:2048
    s_waitcnt lgkmcnt(4)
    ds_read_b64_tr_b16 a[176:177], v218 offset:4096
    ds_read_b64_tr_b16 a[178:179], v218 offset:6144
    ds_read_b64_tr_b16 a[180:181], v219 offset:4096
    ds_read_b64_tr_b16 a[182:183], v219 offset:6144
    ds_read_b64_tr_b16 a[184:185], v220 offset:4096
    ds_read_b64_tr_b16 a[186:187], v220 offset:6144
    ds_read_b64_tr_b16 a[188:189], v221 offset:4096
    ds_read_b64_tr_b16 a[190:191], v221 offset:6144
    s_waitcnt vmcnt(16) lgkmcnt(4)
    ds_read_b64_tr_b16 a[192:193], v210 offset:0
    ds_read_b64_tr_b16 a[194:195], v210 offset:2048
    ds_read_b64_tr_b16 a[196:197], v211 offset:0
    ds_read_b64_tr_b16 a[198:199], v211 offset:2048
    ds_read_b64_tr_b16 a[200:201], v212 offset:0
    ds_read_b64_tr_b16 a[202:203], v212 offset:2048
    ds_read_b64_tr_b16 a[204:205], v213 offset:0
    ds_read_b64_tr_b16 a[206:207], v213 offset:2048
    s_waitcnt lgkmcnt(4)
    ds_read_b64_tr_b16 a[208:209], v210 offset:4096
    ds_read_b64_tr_b16 a[210:211], v210 offset:6144
    ds_read_b64_tr_b16 a[212:213], v211 offset:4096
    ds_read_b64_tr_b16 a[214:215], v211 offset:6144
    ds_read_b64_tr_b16 a[216:217], v212 offset:4096
    ds_read_b64_tr_b16 a[218:219], v212 offset:6144
    ds_read_b64_tr_b16 a[220:221], v213 offset:4096
    ds_read_b64_tr_b16 a[222:223], v213 offset:6144
    s_waitcnt vmcnt(8) lgkmcnt(0)
    s_atomic_swap_x2 s[80:81], s[8:9], 0
    s_add_u32 m0, s55, 65536
    s_nop 0
    buffer_load_dwordx4 v10, s[24:27], s58 offen offset:0 lds
    buffer_load_dwordx4 v11, s[24:27], s58 offen offset:1024 lds
    buffer_load_dwordx4 v12, s[24:27], s58 offen offset:2048 lds
    buffer_load_dwordx4 v13, s[24:27], s58 offen offset:3072 lds
    s_add_u32 m0, s55, 69632
    s_add_u32 s46, s58, 32768
    buffer_load_dwordx4 v10, s[24:27], s46 offen offset:0 lds
    buffer_load_dwordx4 v11, s[24:27], s46 offen offset:1024 lds
    buffer_load_dwordx4 v12, s[24:27], s46 offen offset:2048 lds
    buffer_load_dwordx4 v13, s[24:27], s46 offen offset:3072 lds
    s_add_u32 m0, s55, 98304
    s_nop 0
    buffer_load_dwordx4 v10, s[24:27], s59 offen offset:0 lds
    buffer_load_dwordx4 v11, s[24:27], s59 offen offset:1024 lds
    buffer_load_dwordx4 v12, s[24:27], s59 offen offset:2048 lds
    buffer_load_dwordx4 v13, s[24:27], s59 offen offset:3072 lds
    s_add_u32 m0, s55, 102400
    s_add_u32 s46, s59, 32768
    buffer_load_dwordx4 v10, s[24:27], s46 offen offset:0 lds
    buffer_load_dwordx4 v11, s[24:27], s46 offen offset:1024 lds
    buffer_load_dwordx4 v12, s[24:27], s46 offen offset:2048 lds
    buffer_load_dwordx4 v13, s[24:27], s46 offen offset:3072 lds
    s_waitcnt vmcnt(16) lgkmcnt(4)
    ds_read_b64_tr_b16 a[32:33], v210 offset:32768
    ds_read_b64_tr_b16 a[34:35], v210 offset:34816
    ds_read_b64_tr_b16 a[36:37], v211 offset:32768
    ds_read_b64_tr_b16 a[38:39], v211 offset:34816
    ds_read_b64_tr_b16 a[40:41], v212 offset:32768
    ds_read_b64_tr_b16 a[42:43], v212 offset:34816
    ds_read_b64_tr_b16 a[44:45], v213 offset:32768
    ds_read_b64_tr_b16 a[46:47], v213 offset:34816
    s_waitcnt lgkmcnt(4)
    ds_read_b64_tr_b16 a[48:49], v210 offset:36864
    ds_read_b64_tr_b16 a[50:51], v210 offset:38912
    ds_read_b64_tr_b16 a[52:53], v211 offset:36864
    ds_read_b64_tr_b16 a[54:55], v211 offset:38912
    ds_read_b64_tr_b16 a[56:57], v212 offset:36864
    ds_read_b64_tr_b16 a[58:59], v212 offset:38912
    ds_read_b64_tr_b16 a[60:61], v213 offset:36864
    ds_read_b64_tr_b16 a[62:63], v213 offset:38912
    s_add_u32 m0, s55, 131072
    s_nop 0
    buffer_load_dwordx4 v10, s[24:27], s60 offen offset:0 lds
    buffer_load_dwordx4 v11, s[24:27], s60 offen offset:1024 lds
    buffer_load_dwordx4 v12, s[24:27], s60 offen offset:2048 lds
    buffer_load_dwordx4 v13, s[24:27], s60 offen offset:3072 lds
    s_load_dwordx16 s[64:79], s[82:83], 0 glc
    s_add_u32 m0, s55, 135168
    s_add_u32 s46, s60, 32768
    buffer_load_dwordx4 v10, s[24:27], s46 offen offset:0 lds
    buffer_load_dwordx4 v11, s[24:27], s46 offen offset:1024 lds
    buffer_load_dwordx4 v12, s[24:27], s46 offen offset:2048 lds
    buffer_load_dwordx4 v13, s[24:27], s46 offen offset:3072 lds
    s_mov_b32 s63, 0x40000
    s_branch L_check_V
L_poll_V:
    s_load_dwordx16 s[64:79], s[82:83], 0 glc
    s_sub_u32 s63, s63, 1
    s_cbranch_scc1 L_ready_V
L_check_V:
    s_waitcnt lgkmcnt(0)
    s_cmp_lg_u64 s[64:65], s[80:81]
    s_cbranch_scc1 L_poll_V
    s_cmp_lg_u64 s[66:67], s[80:81]
    s_cbranch_scc1 L_poll_V
    s_cmp_lg_u64 s[68:69], s[80:81]
    s_cbranch_scc1 L_poll_V
    s_cmp_lg_u64 s[70:71], s[80:81]
    s_cbranch_scc1 L_poll_V
    s_cmp_lg_u64 s[72:73], s[80:81]
    s_cbranch_scc1 L_poll_V
    s_cmp_lg_u64 s[74:75], s[80:81]
    s_cbranch_scc1 L_poll_V
    s_cmp_lg_u64 s[76:77], s[80:81]
    s_cbranch_scc1 L_poll_V
L_ready_V:
    buffer_load_dwordx4 v[96:99], v14, s[36:39], s48 offen offset:0 sc1
    buffer_load_dwordx4 v[100:103], v14, s[36:39], s48 offen offset:1024 sc1
    buffer_load_dwordx4 v[104:107], v14, s[36:39], s49 offen offset:0 sc1
    buffer_load_dwordx4 v[108:111], v14, s[36:39], s49 offen offset:1024 sc1
    buffer_load_dwordx4 v[112:115], v14, s[36:39], s50 offen offset:0 sc1
    s_barrier
    buffer_load_dwordx4 v[116:119], v14, s[36:39], s50 offen offset:1024 sc1
    buffer_load_dwordx4 v[120:123], v14, s[36:39], s51 offen offset:0 sc1
    buffer_load_dwordx4 v[124:127], v14, s[36:39], s51 offen offset:1024 sc1
    buffer_load_dwordx4 v[128:131], v14, s[36:39], s52 offen offset:0 sc1
    buffer_load_dwordx4 v[132:135], v14, s[36:39], s52 offen offset:1024 sc1
    s_waitcnt vmcnt(26) lgkmcnt(4)
    ds_read_b64_tr_b16 a[64:65], v214 offset:0
    ds_read_b64_tr_b16 a[66:67], v214 offset:2048
    ds_read_b64_tr_b16 a[68:69], v215 offset:0
    ds_read_b64_tr_b16 a[70:71], v215 offset:2048
    ds_read_b64_tr_b16 a[72:73], v216 offset:0
    ds_read_b64_tr_b16 a[74:75], v216 offset:2048
    ds_read_b64_tr_b16 a[76:77], v217 offset:0
    ds_read_b64_tr_b16 a[78:79], v217 offset:2048
    s_waitcnt lgkmcnt(4)
    ds_read_b64_tr_b16 a[80:81], v214 offset:4096
    ds_read_b64_tr_b16 a[82:83], v214 offset:6144
    ds_read_b64_tr_b16 a[84:85], v215 offset:4096
    ds_read_b64_tr_b16 a[86:87], v215 offset:6144
    ds_read_b64_tr_b16 a[88:89], v216 offset:4096
    ds_read_b64_tr_b16 a[90:91], v216 offset:6144
    ds_read_b64_tr_b16 a[92:93], v217 offset:4096
    ds_read_b64_tr_b16 a[94:95], v217 offset:6144
    s_waitcnt vmcnt(18) lgkmcnt(4)
    ds_read_b64_tr_b16 a[96:97], v214 offset:32768
    ds_read_b64_tr_b16 a[98:99], v214 offset:34816
    ds_read_b64_tr_b16 a[100:101], v215 offset:32768
    ds_read_b64_tr_b16 a[102:103], v215 offset:34816
    ds_read_b64_tr_b16 a[104:105], v216 offset:32768
    ds_read_b64_tr_b16 a[106:107], v216 offset:34816
    ds_read_b64_tr_b16 a[108:109], v217 offset:32768
    ds_read_b64_tr_b16 a[110:111], v217 offset:34816
    s_waitcnt lgkmcnt(4)
    ds_read_b64_tr_b16 a[112:113], v214 offset:36864
    ds_read_b64_tr_b16 a[114:115], v214 offset:38912
    ds_read_b64_tr_b16 a[116:117], v215 offset:36864
    ds_read_b64_tr_b16 a[118:119], v215 offset:38912
    ds_read_b64_tr_b16 a[120:121], v216 offset:36864
    ds_read_b64_tr_b16 a[122:123], v216 offset:38912
    ds_read_b64_tr_b16 a[124:125], v217 offset:36864
    ds_read_b64_tr_b16 a[126:127], v217 offset:38912
    s_waitcnt vmcnt(10) lgkmcnt(4)
    ds_read_b64_tr_b16 a[128:129], v218 offset:0
    ds_read_b64_tr_b16 a[130:131], v218 offset:2048
    ds_read_b64_tr_b16 a[132:133], v219 offset:0
    ds_read_b64_tr_b16 a[134:135], v219 offset:2048
    ds_read_b64_tr_b16 a[136:137], v220 offset:0
    ds_read_b64_tr_b16 a[138:139], v220 offset:2048
    ds_read_b64_tr_b16 a[140:141], v221 offset:0
    ds_read_b64_tr_b16 a[142:143], v221 offset:2048
    s_waitcnt lgkmcnt(4)
    ds_read_b64_tr_b16 a[144:145], v218 offset:4096
    ds_read_b64_tr_b16 a[146:147], v218 offset:6144
    ds_read_b64_tr_b16 a[148:149], v219 offset:4096
    ds_read_b64_tr_b16 a[150:151], v219 offset:6144
    ds_read_b64_tr_b16 a[152:153], v220 offset:4096
    ds_read_b64_tr_b16 a[154:155], v220 offset:6144
    ds_read_b64_tr_b16 a[156:157], v221 offset:4096
    ds_read_b64_tr_b16 a[158:159], v221 offset:6144
    s_branch L_p2
L_code_end:
.section .rodata,"a"
.p2align 6
.amdhsa_kernel standalone__dense_activation_relu__prompt_kernel
  .amdhsa_next_free_vgpr 512
  .amdhsa_next_free_sgpr 102
  .amdhsa_accum_offset 256
  .amdhsa_group_segment_fixed_size 0
  .amdhsa_kernarg_size 48
  .amdhsa_user_sgpr_count 2
  .amdhsa_user_sgpr_kernarg_segment_ptr 1
  .amdhsa_system_sgpr_workgroup_id_x 1
.end_amdhsa_kernel
```
